```python
import torch

def _softmax(x, axis=-1):
    return torch.softmax(x, dim=axis)
def _gelu(x):
    return torch.nn.functional.gelu(x, approximate="tanh")
def _silu(x):
    return torch.nn.functional.silu(x)
def _sigmoid(x):
    return torch.sigmoid(x)
def _layernorm(x, axis=-1, eps=1e-5):
    m = x.mean(dim=axis, keepdim=True)
    v = x.var(dim=axis, keepdim=True, unbiased=False)
    return (x - m) / torch.sqrt(v + eps)
def _scatter_add(tgt, idx, src, axis=0):
    return tgt.clone().index_add_(axis, idx, src)
def _segment_sum(src, seg, n):
    out = torch.zeros((n,) + src.shape[1:], dtype=src.dtype)
    return out.index_add_(0, seg, src)
def _pad(x, pw):
    flat = tuple(v for pair in reversed(pw) for v in pair)
    return torch.nn.functional.pad(x, flat)

kernel_name = 'standalone__softmax_full_bidir__decode'

def setup_inputs():

    _w = (lambda a: (lambda t: t.to(torch.bfloat16) if t.is_floating_point() else t)(torch.as_tensor(a)))
    B, H, Sq, Skv, Dh = 4, 32, 1, 16384, 128
    return {
        "q": _w((lambda *s: torch.randn(*s, dtype=torch.bfloat16) * 0.8)(B, H, Sq, Dh)),
        "k": _w((lambda *s: torch.randn(*s, dtype=torch.bfloat16) * 0.8)(B, H, Skv, Dh)),
        "v": _w((lambda *s: torch.randn(*s, dtype=torch.bfloat16) * 0.05)(B, H, Skv, Dh)),
    }

def reference(q, k, v):
    scale = q.shape[-1] ** -0.5
    scores = torch.einsum('bhqd,bhkd->bhqk', q, k) * scale
    attn = _softmax(scores, axis=-1)
    return torch.einsum('bhqk,bhkd->bhqd', attn, v)
```

```asm
; @launch grid=(256,1,1) block=(64,1,1) lds=90000
.amdgcn_target "amdgcn-amd-amdhsa--gfx950"
.text
.globl standalone__softmax_full_bidir__decode_kernel
.p2align 8
.type standalone__softmax_full_bidir__decode_kernel,@function
standalone__softmax_full_bidir__decode_kernel:
    s_load_dwordx8 s[4:11], s[0:1], 0
    s_load_dwordx4 s[12:15], s[0:1], 32
    s_cmp_ge_u32 s2, 256
    s_cbranch_scc1 L_end1
    s_lshr_b32 s24, s2, 1
    v_and_b32 v13, 15, v0
    v_lshrrev_b32 v14, 4, v0
    v_lshrrev_b32 v16, 2, v13
    v_lshlrev_b32 v16, 8, v16
    v_and_b32 v17, 3, v13
    v_lshlrev_b32 v17, 4, v17
    v_lshlrev_b32 v18, 6, v14
    v_add_u32 v17, v17, v18
    v_add_u32 v1, v16, v17
    v_lshlrev_b32 v2, 4, v0
    s_lshl_b32 s28, s2, 21
    s_mov_b32 s29, 0
    s_lshl_b32 s31, s24, 8
    s_mov_b32 s18, 2097152
    s_mov_b32 s19, 0x00020000
    s_waitcnt lgkmcnt(0)
    s_add_u32 s16, s6, s28
    s_addc_u32 s17, s7, 0
    s_and_b32 s17, s17, 0xffff
    s_add_u32 s4, s4, s31
    s_addc_u32 s5, s5, 0
    global_load_dwordx4 v[20:23], v17, s[4:5]
    s_or_b32 s27, s29, 0x0
    buffer_load_dwordx4 v[56:59], v1, s[16:19], s27 offen offset:0 nt
    buffer_load_dwordx4 v[60:63], v1, s[16:19], s27 offen offset:1024 nt
    buffer_load_dwordx4 v[64:67], v1, s[16:19], s27 offen offset:2048 nt
    buffer_load_dwordx4 v[68:71], v1, s[16:19], s27 offen offset:3072 nt
    s_or_b32 s27, s29, 0x8000
    buffer_load_dwordx4 v[72:75], v1, s[16:19], s27 offen offset:0 nt
    buffer_load_dwordx4 v[76:79], v1, s[16:19], s27 offen offset:1024 nt
    buffer_load_dwordx4 v[80:83], v1, s[16:19], s27 offen offset:2048 nt
    buffer_load_dwordx4 v[84:87], v1, s[16:19], s27 offen offset:3072 nt
    s_or_b32 s27, s29, 0x1000
    buffer_load_dwordx4 v[88:91], v1, s[16:19], s27 offen offset:0 nt
    buffer_load_dwordx4 v[92:95], v1, s[16:19], s27 offen offset:1024 nt
    buffer_load_dwordx4 v[96:99], v1, s[16:19], s27 offen offset:2048 nt
    buffer_load_dwordx4 v[100:103], v1, s[16:19], s27 offen offset:3072 nt
    s_or_b32 s27, s29, 0x9000
    buffer_load_dwordx4 v[104:107], v1, s[16:19], s27 offen offset:0 nt
    buffer_load_dwordx4 v[108:111], v1, s[16:19], s27 offen offset:1024 nt
    buffer_load_dwordx4 v[112:115], v1, s[16:19], s27 offen offset:2048 nt
    buffer_load_dwordx4 v[116:119], v1, s[16:19], s27 offen offset:3072 nt
    s_or_b32 s27, s29, 0x2000
    buffer_load_dwordx4 v[120:123], v1, s[16:19], s27 offen offset:0 nt
    buffer_load_dwordx4 v[124:127], v1, s[16:19], s27 offen offset:1024 nt
    buffer_load_dwordx4 v[128:131], v1, s[16:19], s27 offen offset:2048 nt
    buffer_load_dwordx4 v[132:135], v1, s[16:19], s27 offen offset:3072 nt
    s_add_u32 s20, s8, s28
    s_addc_u32 s21, s9, 0
    s_and_b32 s21, s21, 0xffff
    s_mov_b32 s30, 0x3e0293ee
    s_add_u32 s10, s10, s31
    s_addc_u32 s11, s11, 0
    s_lshl_b32 s28, s2, 10
    s_add_u32 s32, s14, s28
    s_addc_u32 s33, s15, 0
    s_xor_b32 s28, s28, 1024
    s_add_u32 s34, s14, s28
    s_addc_u32 s35, s15, 0
    s_lshr_b32 s28, s2, 2
    s_lshl_b32 s28, s28, 2
    s_add_u32 s36, s12, s28
    s_addc_u32 s37, s13, 0
    s_and_b32 s38, s24, 1
    s_lshl_b32 s38, s38, 4
    v_mov_b32 v52, -1
    v_mov_b32 v53, -1
    v_mov_b32 v54, -1
    v_mov_b32 v55, -1
    global_store_dwordx4 v2, v[52:55], s[32:33] sc0 sc1
    s_add_u32 s22, s14, 0x200000
    s_addc_u32 s23, s15, 0
    s_cmp_ge_u32 s2, 192
    s_cbranch_scc1 L_noinit
    s_mul_i32 s28, s2, 512
    v_mul_u32_u24 v9, 256, v0
    v_add_u32 v9, s28, v9
    v_mov_b32 v10, 0x1000
    s_mov_b64 exec, 3
    global_store_dword v9, v10, s[22:23] sc0 sc1
    s_mov_b64 exec, -1
L_noinit:
    s_mov_b32 s39, 0x6c28480
    s_lshr_b32 s49, s2, 3
    s_and_b32 s57, s2, 7
    s_lshr_b32 s28, s57, 2
    s_xor_b32 s3, s28, s57
    s_and_b32 s3, s3, 1
    s_lshl_b32 s3, s3, 1
    s_or_b32 s3, s3, s28
    s_mul_i32 s3, s3, 0x555
    s_mov_b32 s25, 0
    s_mov_b32 s48, 0
    s_mov_b32 s40, 0x00ff00ff
    s_mov_b32 s41, 0x00ff00ff
    s_mov_b32 s42, 0x22222222
    s_mov_b32 s43, 0x22222222
    s_mov_b32 s44, 0x44444444
    s_mov_b32 s45, 0x44444444
    s_mov_b32 s46, 0x88888888
    s_mov_b32 s47, 0x88888888
    v_and_b32 v24, 1, v13
    v_lshlrev_b32 v24, 4, v24
    v_mov_b32 v25, 0xffff
    v_lshlrev_b32 v24, v24, v25
    s_mov_b32 vcc_lo, 0x00030003
    s_mov_b32 vcc_hi, 0x00030003
    v_cndmask_b32 v28, 0, v24, vcc
    s_mov_b32 vcc_lo, 0x000c000c
    s_mov_b32 vcc_hi, 0x000c000c
    v_cndmask_b32 v29, 0, v24, vcc
    s_mov_b32 vcc_lo, 0x00300030
    s_mov_b32 vcc_hi, 0x00300030
    v_cndmask_b32 v30, 0, v24, vcc
    s_mov_b32 vcc_lo, 0x00c000c0
    s_mov_b32 vcc_hi, 0x00c000c0
    v_cndmask_b32 v31, 0, v24, vcc
    v_mov_b32 v3, 0xff800000
    v_mov_b32 v5, 0
    v_lshlrev_b32 v8, 2, v0
    v_mov_b32 v16, 0
    v_mov_b32 v17, 0
    v_mov_b32 v18, 0
    v_mov_b32 v19, 0
    s_waitcnt vmcnt(20)
    s_mov_b32 vcc_lo, 0x000f000f
    s_mov_b32 vcc_hi, 0x000f000f
    v_cndmask_b32 v32, 0, v20, vcc
    v_cndmask_b32 v33, 0, v21, vcc
    v_cndmask_b32 v34, 0, v22, vcc
    v_cndmask_b32 v35, 0, v23, vcc
    s_mov_b32 vcc_lo, 0x00f000f0
    s_mov_b32 vcc_hi, 0x00f000f0
    v_cndmask_b32 v36, 0, v20, vcc
    v_cndmask_b32 v37, 0, v21, vcc
    v_cndmask_b32 v38, 0, v22, vcc
    v_cndmask_b32 v39, 0, v23, vcc
    s_mov_b32 vcc_lo, 0x0f000f00
    s_mov_b32 vcc_hi, 0x0f000f00
    v_cndmask_b32 v40, 0, v20, vcc
    v_cndmask_b32 v41, 0, v21, vcc
    v_cndmask_b32 v42, 0, v22, vcc
    v_cndmask_b32 v43, 0, v23, vcc
    s_mov_b32 vcc_lo, 0xf000f000
    s_mov_b32 vcc_hi, 0xf000f000
    v_cndmask_b32 v44, 0, v20, vcc
    v_cndmask_b32 v45, 0, v21, vcc
    v_cndmask_b32 v46, 0, v22, vcc
    v_cndmask_b32 v47, 0, v23, vcc
    s_or_b32 s27, s29, 0xa000
    buffer_load_dwordx4 v[136:139], v1, s[16:19], s27 offen offset:0 nt
    buffer_load_dwordx4 v[140:143], v1, s[16:19], s27 offen offset:1024 nt
    buffer_load_dwordx4 v[144:147], v1, s[16:19], s27 offen offset:2048 nt
    buffer_load_dwordx4 v[148:151], v1, s[16:19], s27 offen offset:3072 nt
    s_or_b32 s27, s29, 0x3000
    buffer_load_dwordx4 v[152:155], v1, s[16:19], s27 offen offset:0 nt
    buffer_load_dwordx4 v[156:159], v1, s[16:19], s27 offen offset:1024 nt
    buffer_load_dwordx4 v[160:163], v1, s[16:19], s27 offen offset:2048 nt
    buffer_load_dwordx4 v[164:167], v1, s[16:19], s27 offen offset:3072 nt
    s_or_b32 s27, s29, 0xb000
    buffer_load_dwordx4 v[168:171], v1, s[16:19], s27 offen offset:0 nt
    buffer_load_dwordx4 v[172:175], v1, s[16:19], s27 offen offset:1024 nt
    buffer_load_dwordx4 v[176:179], v1, s[16:19], s27 offen offset:2048 nt
    buffer_load_dwordx4 v[180:183], v1, s[16:19], s27 offen offset:3072 nt
    s_or_b32 s29, s29, 0xffe0bfff
    s_add_u32 s29, s29, 1
    s_and_b32 s29, s29, 0x1f4000
    s_mov_b32 s26, 63
.p2align 3
L_loopK:
    s_cmp_lg_u32 s26, 0
    s_cbranch_scc1 L_kgo
    s_mov_b32 s16, s20
    s_mov_b32 s17, s21
    s_mov_b32 s29, 0
    v_mov_b32 v1, v2
L_kgo:
    s_waitcnt vmcnt(28)
    v_mfma_f32_16x16x32_bf16 v[12:15], v[56:59], v[32:35], 0
    s_or_b32 s27, s29, 0x0
    s_waitcnt vmcnt(19)
    buffer_load_dwordx4 v[56:59], v1, s[16:19], s27 offen offset:0 nt
    v_mfma_f32_16x16x32_bf16 v[12:15], v[60:63], v[36:39], v[12:15]
    s_waitcnt vmcnt(19)
    buffer_load_dwordx4 v[60:63], v1, s[16:19], s27 offen offset:1024 nt
    v_mfma_f32_16x16x32_bf16 v[12:15], v[64:67], v[40:43], v[12:15]
    v_mfma_f32_16x16x32_bf16 v[12:15], v[68:71], v[44:47], v[12:15]
    s_waitcnt vmcnt(19)
    buffer_load_dwordx4 v[64:67], v1, s[16:19], s27 offen offset:2048 nt
    s_nop 5
    v_mov_b32_dpp v6, v12 quad_perm:[0,0,0,0] row_mask:0xf bank_mask:0xf
    v_mov_b32_dpp v9, v14 quad_perm:[2,2,2,2] row_mask:0xf bank_mask:0xf
    s_nop 0
    v_add_f32_dpp v6, v13, v6 quad_perm:[1,1,1,1] row_mask:0xf bank_mask:0xf
    v_add_f32_dpp v9, v15, v9 quad_perm:[3,3,3,3] row_mask:0xf bank_mask:0xf
    v_add_f32 v48, v6, v9
    s_waitcnt vmcnt(18)
    buffer_load_dwordx4 v[68:71], v1, s[16:19], s27 offen offset:3072 nt
    s_waitcnt vmcnt(28)
    v_mfma_f32_16x16x32_bf16 v[12:15], v[72:75], v[32:35], 0
    s_or_b32 s27, s29, 0x8000
    s_waitcnt vmcnt(19)
    buffer_load_dwordx4 v[72:75], v1, s[16:19], s27 offen offset:0 nt
    v_mfma_f32_16x16x32_bf16 v[12:15], v[76:79], v[36:39], v[12:15]
    s_waitcnt vmcnt(19)
    buffer_load_dwordx4 v[76:79], v1, s[16:19], s27 offen offset:1024 nt
    v_mfma_f32_16x16x32_bf16 v[12:15], v[80:83], v[40:43], v[12:15]
    v_mfma_f32_16x16x32_bf16 v[12:15], v[84:87], v[44:47], v[12:15]
    s_waitcnt vmcnt(19)
    buffer_load_dwordx4 v[80:83], v1, s[16:19], s27 offen offset:2048 nt
    s_nop 5
    v_mov_b32_dpp v6, v12 quad_perm:[0,0,0,0] row_mask:0xf bank_mask:0xf
    v_mov_b32_dpp v9, v14 quad_perm:[2,2,2,2] row_mask:0xf bank_mask:0xf
    s_nop 0
    v_add_f32_dpp v6, v13, v6 quad_perm:[1,1,1,1] row_mask:0xf bank_mask:0xf
    v_add_f32_dpp v9, v15, v9 quad_perm:[3,3,3,3] row_mask:0xf bank_mask:0xf
    v_add_f32 v6, v6, v9
    v_cndmask_b32 v48, v48, v6, s[42:43]
    s_waitcnt vmcnt(18)
    buffer_load_dwordx4 v[84:87], v1, s[16:19], s27 offen offset:3072 nt
    s_waitcnt vmcnt(28)
    v_mfma_f32_16x16x32_bf16 v[12:15], v[88:91], v[32:35], 0
    s_or_b32 s27, s29, 0x1000
    s_waitcnt vmcnt(19)
    buffer_load_dwordx4 v[88:91], v1, s[16:19], s27 offen offset:0 nt
    v_mfma_f32_16x16x32_bf16 v[12:15], v[92:95], v[36:39], v[12:15]
    s_waitcnt vmcnt(19)
    buffer_load_dwordx4 v[92:95], v1, s[16:19], s27 offen offset:1024 nt
    v_mfma_f32_16x16x32_bf16 v[12:15], v[96:99], v[40:43], v[12:15]
    v_mfma_f32_16x16x32_bf16 v[12:15], v[100:103], v[44:47], v[12:15]
    s_waitcnt vmcnt(19)
    buffer_load_dwordx4 v[96:99], v1, s[16:19], s27 offen offset:2048 nt
    s_nop 5
    v_mov_b32_dpp v6, v12 quad_perm:[0,0,0,0] row_mask:0xf bank_mask:0xf
    v_mov_b32_dpp v9, v14 quad_perm:[2,2,2,2] row_mask:0xf bank_mask:0xf
    s_nop 0
    v_add_f32_dpp v6, v13, v6 quad_perm:[1,1,1,1] row_mask:0xf bank_mask:0xf
    v_add_f32_dpp v9, v15, v9 quad_perm:[3,3,3,3] row_mask:0xf bank_mask:0xf
    v_add_f32 v6, v6, v9
    v_cndmask_b32 v48, v48, v6, s[44:45]
    s_waitcnt vmcnt(18)
    buffer_load_dwordx4 v[100:103], v1, s[16:19], s27 offen offset:3072 nt
    s_waitcnt vmcnt(28)
    v_mfma_f32_16x16x32_bf16 v[12:15], v[104:107], v[32:35], 0
    s_or_b32 s27, s29, 0x9000
    s_waitcnt vmcnt(19)
    buffer_load_dwordx4 v[104:107], v1, s[16:19], s27 offen offset:0 nt
    v_mfma_f32_16x16x32_bf16 v[12:15], v[108:111], v[36:39], v[12:15]
    s_waitcnt vmcnt(19)
    buffer_load_dwordx4 v[108:111], v1, s[16:19], s27 offen offset:1024 nt
    v_mfma_f32_16x16x32_bf16 v[12:15], v[112:115], v[40:43], v[12:15]
    v_mfma_f32_16x16x32_bf16 v[12:15], v[116:119], v[44:47], v[12:15]
    s_waitcnt vmcnt(19)
    buffer_load_dwordx4 v[112:115], v1, s[16:19], s27 offen offset:2048 nt
    s_nop 5
    v_mov_b32_dpp v6, v12 quad_perm:[0,0,0,0] row_mask:0xf bank_mask:0xf
    v_mov_b32_dpp v9, v14 quad_perm:[2,2,2,2] row_mask:0xf bank_mask:0xf
    s_nop 0
    v_add_f32_dpp v6, v13, v6 quad_perm:[1,1,1,1] row_mask:0xf bank_mask:0xf
    v_add_f32_dpp v9, v15, v9 quad_perm:[3,3,3,3] row_mask:0xf bank_mask:0xf
    v_add_f32 v6, v6, v9
    v_cndmask_b32 v48, v48, v6, s[46:47]
    v_max_f32 v3, v3, v48
    ds_write_b32 v8, v48 offset:0
    s_waitcnt vmcnt(18)
    buffer_load_dwordx4 v[116:119], v1, s[16:19], s27 offen offset:3072 nt
    s_waitcnt vmcnt(28)
    v_mfma_f32_16x16x32_bf16 v[12:15], v[120:123], v[32:35], 0
    s_or_b32 s27, s29, 0x2000
    s_waitcnt vmcnt(19)
    buffer_load_dwordx4 v[120:123], v1, s[16:19], s27 offen offset:0 nt
    v_mfma_f32_16x16x32_bf16 v[12:15], v[124:127], v[36:39], v[12:15]
    s_waitcnt vmcnt(19)
    buffer_load_dwordx4 v[124:127], v1, s[16:19], s27 offen offset:1024 nt
    v_mfma_f32_16x16x32_bf16 v[12:15], v[128:131], v[40:43], v[12:15]
    v_mfma_f32_16x16x32_bf16 v[12:15], v[132:135], v[44:47], v[12:15]
    s_waitcnt vmcnt(19)
    buffer_load_dwordx4 v[128:131], v1, s[16:19], s27 offen offset:2048 nt
    s_nop 5
    v_mov_b32_dpp v6, v12 quad_perm:[0,0,0,0] row_mask:0xf bank_mask:0xf
    v_mov_b32_dpp v9, v14 quad_perm:[2,2,2,2] row_mask:0xf bank_mask:0xf
    s_nop 0
    v_add_f32_dpp v6, v13, v6 quad_perm:[1,1,1,1] row_mask:0xf bank_mask:0xf
    v_add_f32_dpp v9, v15, v9 quad_perm:[3,3,3,3] row_mask:0xf bank_mask:0xf
    v_add_f32 v49, v6, v9
    s_waitcnt vmcnt(18)
    buffer_load_dwordx4 v[132:135], v1, s[16:19], s27 offen offset:3072 nt
    s_waitcnt vmcnt(28)
    v_mfma_f32_16x16x32_bf16 v[12:15], v[136:139], v[32:35], 0
    s_or_b32 s27, s29, 0xa000
    s_waitcnt vmcnt(19)
    buffer_load_dwordx4 v[136:139], v1, s[16:19], s27 offen offset:0 nt
    v_mfma_f32_16x16x32_bf16 v[12:15], v[140:143], v[36:39], v[12:15]
    s_waitcnt vmcnt(19)
    buffer_load_dwordx4 v[140:143], v1, s[16:19], s27 offen offset:1024 nt
    v_mfma_f32_16x16x32_bf16 v[12:15], v[144:147], v[40:43], v[12:15]
    v_mfma_f32_16x16x32_bf16 v[12:15], v[148:151], v[44:47], v[12:15]
    s_waitcnt vmcnt(19)
    buffer_load_dwordx4 v[144:147], v1, s[16:19], s27 offen offset:2048 nt
    s_nop 5
    v_mov_b32_dpp v6, v12 quad_perm:[0,0,0,0] row_mask:0xf bank_mask:0xf
    v_mov_b32_dpp v9, v14 quad_perm:[2,2,2,2] row_mask:0xf bank_mask:0xf
    s_nop 0
    v_add_f32_dpp v6, v13, v6 quad_perm:[1,1,1,1] row_mask:0xf bank_mask:0xf
    v_add_f32_dpp v9, v15, v9 quad_perm:[3,3,3,3] row_mask:0xf bank_mask:0xf
    v_add_f32 v6, v6, v9
    v_cndmask_b32 v49, v49, v6, s[42:43]
    s_waitcnt vmcnt(18)
    buffer_load_dwordx4 v[148:151], v1, s[16:19], s27 offen offset:3072 nt
    s_waitcnt vmcnt(28)
    v_mfma_f32_16x16x32_bf16 v[12:15], v[152:155], v[32:35], 0
    s_or_b32 s27, s29, 0x3000
    s_waitcnt vmcnt(19)
    buffer_load_dwordx4 v[152:155], v1, s[16:19], s27 offen offset:0 nt
    v_mfma_f32_16x16x32_bf16 v[12:15], v[156:159], v[36:39], v[12:15]
    s_waitcnt vmcnt(19)
    buffer_load_dwordx4 v[156:159], v1, s[16:19], s27 offen offset:1024 nt
    v_mfma_f32_16x16x32_bf16 v[12:15], v[160:163], v[40:43], v[12:15]
    v_mfma_f32_16x16x32_bf16 v[12:15], v[164:167], v[44:47], v[12:15]
    s_waitcnt vmcnt(19)
    buffer_load_dwordx4 v[160:163], v1, s[16:19], s27 offen offset:2048 nt
    s_nop 5
    v_mov_b32_dpp v6, v12 quad_perm:[0,0,0,0] row_mask:0xf bank_mask:0xf
    v_mov_b32_dpp v9, v14 quad_perm:[2,2,2,2] row_mask:0xf bank_mask:0xf
    s_nop 0
    v_add_f32_dpp v6, v13, v6 quad_perm:[1,1,1,1] row_mask:0xf bank_mask:0xf
    v_add_f32_dpp v9, v15, v9 quad_perm:[3,3,3,3] row_mask:0xf bank_mask:0xf
    v_add_f32 v6, v6, v9
    v_cndmask_b32 v49, v49, v6, s[44:45]
    s_waitcnt vmcnt(18)
    buffer_load_dwordx4 v[164:167], v1, s[16:19], s27 offen offset:3072 nt
    s_waitcnt vmcnt(28)
    v_mfma_f32_16x16x32_bf16 v[12:15], v[168:171], v[32:35], 0
    s_or_b32 s27, s29, 0xb000
    s_waitcnt vmcnt(19)
    buffer_load_dwordx4 v[168:171], v1, s[16:19], s27 offen offset:0 nt
    v_mfma_f32_16x16x32_bf16 v[12:15], v[172:175], v[36:39], v[12:15]
    s_waitcnt vmcnt(19)
    buffer_load_dwordx4 v[172:175], v1, s[16:19], s27 offen offset:1024 nt
    v_mfma_f32_16x16x32_bf16 v[12:15], v[176:179], v[40:43], v[12:15]
    v_mfma_f32_16x16x32_bf16 v[12:15], v[180:183], v[44:47], v[12:15]
    s_waitcnt vmcnt(19)
    buffer_load_dwordx4 v[176:179], v1, s[16:19], s27 offen offset:2048 nt
    s_nop 5
    v_mov_b32_dpp v6, v12 quad_perm:[0,0,0,0] row_mask:0xf bank_mask:0xf
    v_mov_b32_dpp v9, v14 quad_perm:[2,2,2,2] row_mask:0xf bank_mask:0xf
    s_nop 0
    v_add_f32_dpp v6, v13, v6 quad_perm:[1,1,1,1] row_mask:0xf bank_mask:0xf
    v_add_f32_dpp v9, v15, v9 quad_perm:[3,3,3,3] row_mask:0xf bank_mask:0xf
    v_add_f32 v6, v6, v9
    v_cndmask_b32 v49, v49, v6, s[46:47]
    v_max_f32 v3, v3, v49
    ds_write_b32 v8, v49 offset:256
    s_waitcnt vmcnt(18)
    buffer_load_dwordx4 v[180:183], v1, s[16:19], s27 offen offset:3072 nt
    s_or_b32 s29, s29, 0xffe0bfff
    s_add_u32 s29, s29, 1
    s_and_b32 s29, s29, 0x1f4000
    v_add_u32 v8, 512, v8
    s_sub_u32 s26, s26, 1
    s_cbranch_scc0 L_loopK
L_trans:
    v_lshlrev_b32 v8, 2, v0
    ds_read_b32 v48, v8
    ds_read_b32 v49, v8 offset:256
    ds_read_b32 v11, v8
    s_nop 1
    v_max_f32_dpp v3, v3, v3 row_ror:1 row_mask:0xf bank_mask:0xf
    s_nop 1
    v_max_f32_dpp v3, v3, v3 row_ror:2 row_mask:0xf bank_mask:0xf
    s_nop 1
    v_max_f32_dpp v3, v3, v3 row_ror:4 row_mask:0xf bank_mask:0xf
    s_nop 1
    v_max_f32_dpp v3, v3, v3 row_ror:8 row_mask:0xf bank_mask:0xf
    v_mov_b32 v9, v3
    s_nop 1
    v_permlane16_swap_b32 v3, v9
    s_nop 1
    v_max_f32 v3, v3, v9
    v_mov_b32 v9, v3
    s_nop 1
    v_permlane32_swap_b32 v3, v9
    s_nop 1
    v_max_f32 v3, v3, v9
    v_mul_f32 v4, s30, v3
    s_mov_b32 s26, 63
    s_mov_b32 s58, 0x40040420
    s_mov_b32 s59, 0x10001000
.p2align 3
L_loopV:
    v_add_u32 v8, 512, v8
    s_waitcnt lgkmcnt(1)
    v_fma_f32 v6, v48, s30, -v4
    v_fma_f32 v7, v49, s30, -v4
    v_exp_f32 v6, v6
    v_exp_f32 v7, v7
    ds_read_b32 v48, v8
    ds_read_b32 v49, v8 offset:256
    ds_read_b32 v11, v8
    v_cvt_pk_bf16_f32 v50, v6, v6
    v_cvt_pk_bf16_f32 v51, v7, v7
    v_add_f32 v5, v5, v6
    v_add_f32 v5, v5, v7
    s_cmp_lg_u32 s26, 2
    s_cbranch_scc1 L_noann
    s_lshl_b32 s31, 1, s38
    s_atomic_add s31, s[36:37], 0x0 glc
L_noann:
    s_cmp_ge_u32 s25, 0x1000
    s_cselect_b32 s48, s25, s48
    s_bitcmp1_b64 s[58:59], s26
    s_cbranch_scc0 L_nosV
    s_and_b32 s28, s39, 31
    s_lshr_b32 s39, s39, 5
    s_mul_i32 s28, s28, s57
    s_add_u32 s28, s28, s49
    s_and_b32 s28, s28, 31
    s_lshl_b32 s28, s28, 1
    s_and_b32 s27, s3, 1
    s_lshr_b32 s3, s3, 1
    s_or_b32 s28, s28, s27
    s_mul_i32 s28, s28, 256
    s_waitcnt lgkmcnt(0)
    s_mov_b32 s25, 1
    s_atomic_add s25, s[22:23], s28 glc
    s_add_u32 s22, s22, 16384
    s_addc_u32 s23, s23, 0
L_nosV:
    s_cmp_ge_u32 s48, 0x1003
    s_cbranch_scc1 L_V3
    s_cmp_ge_u32 s48, 0x1002
    s_cbranch_scc1 L_V2
    s_cmp_ge_u32 s48, 0x1001
    s_cbranch_scc1 L_V1
    s_cmp_lg_u32 s48, 0
    s_cbranch_scc1 L_V0
    v_and_b32_dpp v20, v50, v28 row_newbcast:0 row_mask:0xf bank_mask:0xf
    v_and_b32_dpp v21, v50, v29 row_newbcast:0 row_mask:0xf bank_mask:0xf
    v_and_b32_dpp v22, v50, v30 row_newbcast:0 row_mask:0xf bank_mask:0xf
    v_and_b32_dpp v23, v50, v31 row_newbcast:0 row_mask:0xf bank_mask:0xf
    v_and_b32_dpp v24, v50, v28 row_newbcast:4 row_mask:0xf bank_mask:0xf
    v_and_b32_dpp v25, v50, v29 row_newbcast:4 row_mask:0xf bank_mask:0xf
    v_and_b32_dpp v26, v50, v30 row_newbcast:4 row_mask:0xf bank_mask:0xf
    v_and_b32_dpp v27, v50, v31 row_newbcast:4 row_mask:0xf bank_mask:0xf
    s_waitcnt vmcnt(28)
    v_mfma_f32_16x16x32_bf16 v[16:19], v[56:59], v[20:23], v[16:19]
    s_or_b32 s27, s29, 0x0
    s_waitcnt vmcnt(20)
    buffer_load_dwordx4 v[56:59], v1, s[16:19], s27 offen offset:0 nt
    v_and_b32_dpp v20, v50, v28 row_newbcast:8 row_mask:0xf bank_mask:0xf
    v_and_b32_dpp v21, v50, v29 row_newbcast:8 row_mask:0xf bank_mask:0xf
    v_and_b32_dpp v22, v50, v30 row_newbcast:8 row_mask:0xf bank_mask:0xf
    v_and_b32_dpp v23, v50, v31 row_newbcast:8 row_mask:0xf bank_mask:0xf
    v_mfma_f32_16x16x32_bf16 v[16:19], v[60:63], v[24:27], v[16:19]
    s_waitcnt vmcnt(19)
    buffer_load_dwordx4 v[60:63], v1, s[16:19], s27 offen offset:1024 nt
    v_and_b32_dpp v24, v50, v28 row_newbcast:12 row_mask:0xf bank_mask:0xf
    v_and_b32_dpp v25, v50, v29 row_newbcast:12 row_mask:0xf bank_mask:0xf
    v_and_b32_dpp v26, v50, v30 row_newbcast:12 row_mask:0xf bank_mask:0xf
    v_and_b32_dpp v27, v50, v31 row_newbcast:12 row_mask:0xf bank_mask:0xf
    v_mfma_f32_16x16x32_bf16 v[16:19], v[64:67], v[20:23], v[16:19]
    s_waitcnt vmcnt(20)
    buffer_load_dwordx4 v[64:67], v1, s[16:19], s27 offen offset:2048 nt
    v_mfma_f32_16x16x32_bf16 v[16:19], v[68:71], v[24:27], v[16:19]
    s_waitcnt vmcnt(19)
    buffer_load_dwordx4 v[68:71], v1, s[16:19], s27 offen offset:3072 nt
    v_and_b32_dpp v20, v50, v28 row_newbcast:1 row_mask:0xf bank_mask:0xf
    v_and_b32_dpp v21, v50, v29 row_newbcast:1 row_mask:0xf bank_mask:0xf
    v_and_b32_dpp v22, v50, v30 row_newbcast:1 row_mask:0xf bank_mask:0xf
    v_and_b32_dpp v23, v50, v31 row_newbcast:1 row_mask:0xf bank_mask:0xf
    v_and_b32_dpp v24, v50, v28 row_newbcast:5 row_mask:0xf bank_mask:0xf
    v_and_b32_dpp v25, v50, v29 row_newbcast:5 row_mask:0xf bank_mask:0xf
    v_and_b32_dpp v26, v50, v30 row_newbcast:5 row_mask:0xf bank_mask:0xf
    v_and_b32_dpp v27, v50, v31 row_newbcast:5 row_mask:0xf bank_mask:0xf
    s_waitcnt vmcnt(28)
    v_mfma_f32_16x16x32_bf16 v[16:19], v[72:75], v[20:23], v[16:19]
    s_or_b32 s27, s29, 0x8000
    s_waitcnt vmcnt(20)
    buffer_load_dwordx4 v[72:75], v1, s[16:19], s27 offen offset:0 nt
    v_and_b32_dpp v20, v50, v28 row_newbcast:9 row_mask:0xf bank_mask:0xf
    v_and_b32_dpp v21, v50, v29 row_newbcast:9 row_mask:0xf bank_mask:0xf
    v_and_b32_dpp v22, v50, v30 row_newbcast:9 row_mask:0xf bank_mask:0xf
    v_and_b32_dpp v23, v50, v31 row_newbcast:9 row_mask:0xf bank_mask:0xf
    v_mfma_f32_16x16x32_bf16 v[16:19], v[76:79], v[24:27], v[16:19]
    s_waitcnt vmcnt(19)
    buffer_load_dwordx4 v[76:79], v1, s[16:19], s27 offen offset:1024 nt
    v_and_b32_dpp v24, v50, v28 row_newbcast:13 row_mask:0xf bank_mask:0xf
    v_and_b32_dpp v25, v50, v29 row_newbcast:13 row_mask:0xf bank_mask:0xf
    v_and_b32_dpp v26, v50, v30 row_newbcast:13 row_mask:0xf bank_mask:0xf
    v_and_b32_dpp v27, v50, v31 row_newbcast:13 row_mask:0xf bank_mask:0xf
    v_mfma_f32_16x16x32_bf16 v[16:19], v[80:83], v[20:23], v[16:19]
    s_waitcnt vmcnt(20)
    buffer_load_dwordx4 v[80:83], v1, s[16:19], s27 offen offset:2048 nt
    v_mfma_f32_16x16x32_bf16 v[16:19], v[84:87], v[24:27], v[16:19]
    s_waitcnt vmcnt(19)
    buffer_load_dwordx4 v[84:87], v1, s[16:19], s27 offen offset:3072 nt
    v_and_b32_dpp v20, v50, v28 row_newbcast:2 row_mask:0xf bank_mask:0xf
    v_and_b32_dpp v21, v50, v29 row_newbcast:2 row_mask:0xf bank_mask:0xf
    v_and_b32_dpp v22, v50, v30 row_newbcast:2 row_mask:0xf bank_mask:0xf
    v_and_b32_dpp v23, v50, v31 row_newbcast:2 row_mask:0xf bank_mask:0xf
    v_and_b32_dpp v24, v50, v28 row_newbcast:6 row_mask:0xf bank_mask:0xf
    v_and_b32_dpp v25, v50, v29 row_newbcast:6 row_mask:0xf bank_mask:0xf
    v_and_b32_dpp v26, v50, v30 row_newbcast:6 row_mask:0xf bank_mask:0xf
    v_and_b32_dpp v27, v50, v31 row_newbcast:6 row_mask:0xf bank_mask:0xf
    s_waitcnt vmcnt(28)
    v_mfma_f32_16x16x32_bf16 v[16:19], v[88:91], v[20:23], v[16:19]
    s_or_b32 s27, s29, 0x1000
    s_waitcnt vmcnt(20)
    buffer_load_dwordx4 v[88:91], v1, s[16:19], s27 offen offset:0 nt
    v_and_b32_dpp v20, v50, v28 row_newbcast:10 row_mask:0xf bank_mask:0xf
    v_and_b32_dpp v21, v50, v29 row_newbcast:10 row_mask:0xf bank_mask:0xf
    v_and_b32_dpp v22, v50, v30 row_newbcast:10 row_mask:0xf bank_mask:0xf
    v_and_b32_dpp v23, v50, v31 row_newbcast:10 row_mask:0xf bank_mask:0xf
    v_mfma_f32_16x16x32_bf16 v[16:19], v[92:95], v[24:27], v[16:19]
    s_waitcnt vmcnt(19)
    buffer_load_dwordx4 v[92:95], v1, s[16:19], s27 offen offset:1024 nt
    v_and_b32_dpp v24, v50, v28 row_newbcast:14 row_mask:0xf bank_mask:0xf
    v_and_b32_dpp v25, v50, v29 row_newbcast:14 row_mask:0xf bank_mask:0xf
    v_and_b32_dpp v26, v50, v30 row_newbcast:14 row_mask:0xf bank_mask:0xf
    v_and_b32_dpp v27, v50, v31 row_newbcast:14 row_mask:0xf bank_mask:0xf
    v_mfma_f32_16x16x32_bf16 v[16:19], v[96:99], v[20:23], v[16:19]
    s_waitcnt vmcnt(20)
    buffer_load_dwordx4 v[96:99], v1, s[16:19], s27 offen offset:2048 nt
    v_mfma_f32_16x16x32_bf16 v[16:19], v[100:103], v[24:27], v[16:19]
    s_waitcnt vmcnt(19)
    buffer_load_dwordx4 v[100:103], v1, s[16:19], s27 offen offset:3072 nt
    v_and_b32_dpp v20, v50, v28 row_newbcast:3 row_mask:0xf bank_mask:0xf
    v_and_b32_dpp v21, v50, v29 row_newbcast:3 row_mask:0xf bank_mask:0xf
    v_and_b32_dpp v22, v50, v30 row_newbcast:3 row_mask:0xf bank_mask:0xf
    v_and_b32_dpp v23, v50, v31 row_newbcast:3 row_mask:0xf bank_mask:0xf
    v_and_b32_dpp v24, v50, v28 row_newbcast:7 row_mask:0xf bank_mask:0xf
    v_and_b32_dpp v25, v50, v29 row_newbcast:7 row_mask:0xf bank_mask:0xf
    v_and_b32_dpp v26, v50, v30 row_newbcast:7 row_mask:0xf bank_mask:0xf
    v_and_b32_dpp v27, v50, v31 row_newbcast:7 row_mask:0xf bank_mask:0xf
    s_waitcnt vmcnt(28)
    v_mfma_f32_16x16x32_bf16 v[16:19], v[104:107], v[20:23], v[16:19]
    s_or_b32 s27, s29, 0x9000
    s_waitcnt vmcnt(20)
    buffer_load_dwordx4 v[104:107], v1, s[16:19], s27 offen offset:0 nt
    v_and_b32_dpp v20, v50, v28 row_newbcast:11 row_mask:0xf bank_mask:0xf
    v_and_b32_dpp v21, v50, v29 row_newbcast:11 row_mask:0xf bank_mask:0xf
    v_and_b32_dpp v22, v50, v30 row_newbcast:11 row_mask:0xf bank_mask:0xf
    v_and_b32_dpp v23, v50, v31 row_newbcast:11 row_mask:0xf bank_mask:0xf
    v_mfma_f32_16x16x32_bf16 v[16:19], v[108:111], v[24:27], v[16:19]
    s_waitcnt vmcnt(19)
    buffer_load_dwordx4 v[108:111], v1, s[16:19], s27 offen offset:1024 nt
    v_and_b32_dpp v24, v50, v28 row_newbcast:15 row_mask:0xf bank_mask:0xf
    v_and_b32_dpp v25, v50, v29 row_newbcast:15 row_mask:0xf bank_mask:0xf
    v_and_b32_dpp v26, v50, v30 row_newbcast:15 row_mask:0xf bank_mask:0xf
    v_and_b32_dpp v27, v50, v31 row_newbcast:15 row_mask:0xf bank_mask:0xf
    v_mfma_f32_16x16x32_bf16 v[16:19], v[112:115], v[20:23], v[16:19]
    s_waitcnt vmcnt(20)
    buffer_load_dwordx4 v[112:115], v1, s[16:19], s27 offen offset:2048 nt
    v_mfma_f32_16x16x32_bf16 v[16:19], v[116:119], v[24:27], v[16:19]
    s_waitcnt vmcnt(19)
    buffer_load_dwordx4 v[116:119], v1, s[16:19], s27 offen offset:3072 nt
    v_and_b32_dpp v20, v51, v28 row_newbcast:0 row_mask:0xf bank_mask:0xf
    v_and_b32_dpp v21, v51, v29 row_newbcast:0 row_mask:0xf bank_mask:0xf
    v_and_b32_dpp v22, v51, v30 row_newbcast:0 row_mask:0xf bank_mask:0xf
    v_and_b32_dpp v23, v51, v31 row_newbcast:0 row_mask:0xf bank_mask:0xf
    v_and_b32_dpp v24, v51, v28 row_newbcast:4 row_mask:0xf bank_mask:0xf
    v_and_b32_dpp v25, v51, v29 row_newbcast:4 row_mask:0xf bank_mask:0xf
    v_and_b32_dpp v26, v51, v30 row_newbcast:4 row_mask:0xf bank_mask:0xf
    v_and_b32_dpp v27, v51, v31 row_newbcast:4 row_mask:0xf bank_mask:0xf
    s_waitcnt vmcnt(28)
    v_mfma_f32_16x16x32_bf16 v[16:19], v[120:123], v[20:23], v[16:19]
    s_or_b32 s27, s29, 0x2000
    s_waitcnt vmcnt(20)
    buffer_load_dwordx4 v[120:123], v1, s[16:19], s27 offen offset:0 nt
    v_and_b32_dpp v20, v51, v28 row_newbcast:8 row_mask:0xf bank_mask:0xf
    v_and_b32_dpp v21, v51, v29 row_newbcast:8 row_mask:0xf bank_mask:0xf
    v_and_b32_dpp v22, v51, v30 row_newbcast:8 row_mask:0xf bank_mask:0xf
    v_and_b32_dpp v23, v51, v31 row_newbcast:8 row_mask:0xf bank_mask:0xf
    v_mfma_f32_16x16x32_bf16 v[16:19], v[124:127], v[24:27], v[16:19]
    s_waitcnt vmcnt(19)
    buffer_load_dwordx4 v[124:127], v1, s[16:19], s27 offen offset:1024 nt
    v_and_b32_dpp v24, v51, v28 row_newbcast:12 row_mask:0xf bank_mask:0xf
    v_and_b32_dpp v25, v51, v29 row_newbcast:12 row_mask:0xf bank_mask:0xf
    v_and_b32_dpp v26, v51, v30 row_newbcast:12 row_mask:0xf bank_mask:0xf
    v_and_b32_dpp v27, v51, v31 row_newbcast:12 row_mask:0xf bank_mask:0xf
    v_mfma_f32_16x16x32_bf16 v[16:19], v[128:131], v[20:23], v[16:19]
    s_waitcnt vmcnt(20)
    buffer_load_dwordx4 v[128:131], v1, s[16:19], s27 offen offset:2048 nt
    v_mfma_f32_16x16x32_bf16 v[16:19], v[132:135], v[24:27], v[16:19]
    s_waitcnt vmcnt(19)
    buffer_load_dwordx4 v[132:135], v1, s[16:19], s27 offen offset:3072 nt
    v_and_b32_dpp v20, v51, v28 row_newbcast:1 row_mask:0xf bank_mask:0xf
    v_and_b32_dpp v21, v51, v29 row_newbcast:1 row_mask:0xf bank_mask:0xf
    v_and_b32_dpp v22, v51, v30 row_newbcast:1 row_mask:0xf bank_mask:0xf
    v_and_b32_dpp v23, v51, v31 row_newbcast:1 row_mask:0xf bank_mask:0xf
    v_and_b32_dpp v24, v51, v28 row_newbcast:5 row_mask:0xf bank_mask:0xf
    v_and_b32_dpp v25, v51, v29 row_newbcast:5 row_mask:0xf bank_mask:0xf
    v_and_b32_dpp v26, v51, v30 row_newbcast:5 row_mask:0xf bank_mask:0xf
    v_and_b32_dpp v27, v51, v31 row_newbcast:5 row_mask:0xf bank_mask:0xf
    s_waitcnt vmcnt(28)
    v_mfma_f32_16x16x32_bf16 v[16:19], v[136:139], v[20:23], v[16:19]
    s_or_b32 s27, s29, 0xa000
    s_waitcnt vmcnt(20)
    buffer_load_dwordx4 v[136:139], v1, s[16:19], s27 offen offset:0 nt
    v_and_b32_dpp v20, v51, v28 row_newbcast:9 row_mask:0xf bank_mask:0xf
    v_and_b32_dpp v21, v51, v29 row_newbcast:9 row_mask:0xf bank_mask:0xf
    v_and_b32_dpp v22, v51, v30 row_newbcast:9 row_mask:0xf bank_mask:0xf
    v_and_b32_dpp v23, v51, v31 row_newbcast:9 row_mask:0xf bank_mask:0xf
    v_mfma_f32_16x16x32_bf16 v[16:19], v[140:143], v[24:27], v[16:19]
    s_waitcnt vmcnt(19)
    buffer_load_dwordx4 v[140:143], v1, s[16:19], s27 offen offset:1024 nt
    v_and_b32_dpp v24, v51, v28 row_newbcast:13 row_mask:0xf bank_mask:0xf
    v_and_b32_dpp v25, v51, v29 row_newbcast:13 row_mask:0xf bank_mask:0xf
    v_and_b32_dpp v26, v51, v30 row_newbcast:13 row_mask:0xf bank_mask:0xf
    v_and_b32_dpp v27, v51, v31 row_newbcast:13 row_mask:0xf bank_mask:0xf
    v_mfma_f32_16x16x32_bf16 v[16:19], v[144:147], v[20:23], v[16:19]
    s_waitcnt vmcnt(20)
    buffer_load_dwordx4 v[144:147], v1, s[16:19], s27 offen offset:2048 nt
    v_mfma_f32_16x16x32_bf16 v[16:19], v[148:151], v[24:27], v[16:19]
    s_waitcnt vmcnt(19)
    buffer_load_dwordx4 v[148:151], v1, s[16:19], s27 offen offset:3072 nt
    v_and_b32_dpp v20, v51, v28 row_newbcast:2 row_mask:0xf bank_mask:0xf
    v_and_b32_dpp v21, v51, v29 row_newbcast:2 row_mask:0xf bank_mask:0xf
    v_and_b32_dpp v22, v51, v30 row_newbcast:2 row_mask:0xf bank_mask:0xf
    v_and_b32_dpp v23, v51, v31 row_newbcast:2 row_mask:0xf bank_mask:0xf
    v_and_b32_dpp v24, v51, v28 row_newbcast:6 row_mask:0xf bank_mask:0xf
    v_and_b32_dpp v25, v51, v29 row_newbcast:6 row_mask:0xf bank_mask:0xf
    v_and_b32_dpp v26, v51, v30 row_newbcast:6 row_mask:0xf bank_mask:0xf
    v_and_b32_dpp v27, v51, v31 row_newbcast:6 row_mask:0xf bank_mask:0xf
    s_waitcnt vmcnt(28)
    v_mfma_f32_16x16x32_bf16 v[16:19], v[152:155], v[20:23], v[16:19]
    s_or_b32 s27, s29, 0x3000
    s_waitcnt vmcnt(20)
    buffer_load_dwordx4 v[152:155], v1, s[16:19], s27 offen offset:0 nt
    v_and_b32_dpp v20, v51, v28 row_newbcast:10 row_mask:0xf bank_mask:0xf
    v_and_b32_dpp v21, v51, v29 row_newbcast:10 row_mask:0xf bank_mask:0xf
    v_and_b32_dpp v22, v51, v30 row_newbcast:10 row_mask:0xf bank_mask:0xf
    v_and_b32_dpp v23, v51, v31 row_newbcast:10 row_mask:0xf bank_mask:0xf
    v_mfma_f32_16x16x32_bf16 v[16:19], v[156:159], v[24:27], v[16:19]
    s_waitcnt vmcnt(19)
    buffer_load_dwordx4 v[156:159], v1, s[16:19], s27 offen offset:1024 nt
    v_and_b32_dpp v24, v51, v28 row_newbcast:14 row_mask:0xf bank_mask:0xf
    v_and_b32_dpp v25, v51, v29 row_newbcast:14 row_mask:0xf bank_mask:0xf
    v_and_b32_dpp v26, v51, v30 row_newbcast:14 row_mask:0xf bank_mask:0xf
    v_and_b32_dpp v27, v51, v31 row_newbcast:14 row_mask:0xf bank_mask:0xf
    v_mfma_f32_16x16x32_bf16 v[16:19], v[160:163], v[20:23], v[16:19]
    s_waitcnt vmcnt(20)
    buffer_load_dwordx4 v[160:163], v1, s[16:19], s27 offen offset:2048 nt
    v_mfma_f32_16x16x32_bf16 v[16:19], v[164:167], v[24:27], v[16:19]
    s_waitcnt vmcnt(19)
    buffer_load_dwordx4 v[164:167], v1, s[16:19], s27 offen offset:3072 nt
    v_and_b32_dpp v20, v51, v28 row_newbcast:3 row_mask:0xf bank_mask:0xf
    v_and_b32_dpp v21, v51, v29 row_newbcast:3 row_mask:0xf bank_mask:0xf
    v_and_b32_dpp v22, v51, v30 row_newbcast:3 row_mask:0xf bank_mask:0xf
    v_and_b32_dpp v23, v51, v31 row_newbcast:3 row_mask:0xf bank_mask:0xf
    v_and_b32_dpp v24, v51, v28 row_newbcast:7 row_mask:0xf bank_mask:0xf
    v_and_b32_dpp v25, v51, v29 row_newbcast:7 row_mask:0xf bank_mask:0xf
    v_and_b32_dpp v26, v51, v30 row_newbcast:7 row_mask:0xf bank_mask:0xf
    v_and_b32_dpp v27, v51, v31 row_newbcast:7 row_mask:0xf bank_mask:0xf
    s_waitcnt vmcnt(28)
    v_mfma_f32_16x16x32_bf16 v[16:19], v[168:171], v[20:23], v[16:19]
    s_or_b32 s27, s29, 0xb000
    s_waitcnt vmcnt(20)
    buffer_load_dwordx4 v[168:171], v1, s[16:19], s27 offen offset:0 nt
    v_and_b32_dpp v20, v51, v28 row_newbcast:11 row_mask:0xf bank_mask:0xf
    v_and_b32_dpp v21, v51, v29 row_newbcast:11 row_mask:0xf bank_mask:0xf
    v_and_b32_dpp v22, v51, v30 row_newbcast:11 row_mask:0xf bank_mask:0xf
    v_and_b32_dpp v23, v51, v31 row_newbcast:11 row_mask:0xf bank_mask:0xf
    v_mfma_f32_16x16x32_bf16 v[16:19], v[172:175], v[24:27], v[16:19]
    s_waitcnt vmcnt(19)
    buffer_load_dwordx4 v[172:175], v1, s[16:19], s27 offen offset:1024 nt
    v_and_b32_dpp v24, v51, v28 row_newbcast:15 row_mask:0xf bank_mask:0xf
    v_and_b32_dpp v25, v51, v29 row_newbcast:15 row_mask:0xf bank_mask:0xf
    v_and_b32_dpp v26, v51, v30 row_newbcast:15 row_mask:0xf bank_mask:0xf
    v_and_b32_dpp v27, v51, v31 row_newbcast:15 row_mask:0xf bank_mask:0xf
    v_mfma_f32_16x16x32_bf16 v[16:19], v[176:179], v[20:23], v[16:19]
    s_waitcnt vmcnt(20)
    buffer_load_dwordx4 v[176:179], v1, s[16:19], s27 offen offset:2048 nt
    v_mfma_f32_16x16x32_bf16 v[16:19], v[180:183], v[24:27], v[16:19]
    s_waitcnt vmcnt(19)
    buffer_load_dwordx4 v[180:183], v1, s[16:19], s27 offen offset:3072 nt
    s_or_b32 s29, s29, 0xffe0bfff
    s_add_u32 s29, s29, 1
    s_and_b32 s29, s29, 0x1f4000
    s_sub_u32 s26, s26, 1
    s_cmp_lg_u32 s26, 0
    s_cbranch_scc1 L_loopV
    s_branch L_last
.p2align 3
L_V0:
    v_and_b32_dpp v20, v50, v28 row_newbcast:0 row_mask:0xf bank_mask:0xf
    v_and_b32_dpp v21, v50, v29 row_newbcast:0 row_mask:0xf bank_mask:0xf
    v_and_b32_dpp v22, v50, v30 row_newbcast:0 row_mask:0xf bank_mask:0xf
    v_and_b32_dpp v23, v50, v31 row_newbcast:0 row_mask:0xf bank_mask:0xf
    v_and_b32_dpp v24, v50, v28 row_newbcast:4 row_mask:0xf bank_mask:0xf
    v_and_b32_dpp v25, v50, v29 row_newbcast:4 row_mask:0xf bank_mask:0xf
    v_and_b32_dpp v26, v50, v30 row_newbcast:4 row_mask:0xf bank_mask:0xf
    v_and_b32_dpp v27, v50, v31 row_newbcast:4 row_mask:0xf bank_mask:0xf
    s_waitcnt vmcnt(28)
    v_mfma_f32_16x16x32_bf16 v[16:19], v[56:59], v[20:23], v[16:19]
    s_or_b32 s27, s29, 0x0
    s_waitcnt vmcnt(17)
    buffer_load_dwordx4 v[56:59], v1, s[16:19], s27 offen offset:0 nt
    v_and_b32_dpp v20, v50, v28 row_newbcast:8 row_mask:0xf bank_mask:0xf
    v_and_b32_dpp v21, v50, v29 row_newbcast:8 row_mask:0xf bank_mask:0xf
    v_and_b32_dpp v22, v50, v30 row_newbcast:8 row_mask:0xf bank_mask:0xf
    v_and_b32_dpp v23, v50, v31 row_newbcast:8 row_mask:0xf bank_mask:0xf
    v_mfma_f32_16x16x32_bf16 v[16:19], v[60:63], v[24:27], v[16:19]
    s_waitcnt vmcnt(16)
    buffer_load_dwordx4 v[60:63], v1, s[16:19], s27 offen offset:1024 nt
    v_and_b32_dpp v24, v50, v28 row_newbcast:12 row_mask:0xf bank_mask:0xf
    v_and_b32_dpp v25, v50, v29 row_newbcast:12 row_mask:0xf bank_mask:0xf
    v_and_b32_dpp v26, v50, v30 row_newbcast:12 row_mask:0xf bank_mask:0xf
    v_and_b32_dpp v27, v50, v31 row_newbcast:12 row_mask:0xf bank_mask:0xf
    v_mfma_f32_16x16x32_bf16 v[16:19], v[64:67], v[20:23], v[16:19]
    s_waitcnt vmcnt(17)
    buffer_load_dwordx4 v[64:67], v1, s[16:19], s27 offen offset:2048 nt
    v_mfma_f32_16x16x32_bf16 v[16:19], v[68:71], v[24:27], v[16:19]
    s_waitcnt vmcnt(16)
    buffer_load_dwordx4 v[68:71], v1, s[16:19], s27 offen offset:3072 nt
    v_and_b32_dpp v20, v50, v28 row_newbcast:1 row_mask:0xf bank_mask:0xf
    v_and_b32_dpp v21, v50, v29 row_newbcast:1 row_mask:0xf bank_mask:0xf
    v_and_b32_dpp v22, v50, v30 row_newbcast:1 row_mask:0xf bank_mask:0xf
    v_and_b32_dpp v23, v50, v31 row_newbcast:1 row_mask:0xf bank_mask:0xf
    v_and_b32_dpp v24, v50, v28 row_newbcast:5 row_mask:0xf bank_mask:0xf
    v_and_b32_dpp v25, v50, v29 row_newbcast:5 row_mask:0xf bank_mask:0xf
    v_and_b32_dpp v26, v50, v30 row_newbcast:5 row_mask:0xf bank_mask:0xf
    v_and_b32_dpp v27, v50, v31 row_newbcast:5 row_mask:0xf bank_mask:0xf
    s_waitcnt vmcnt(28)
    v_mfma_f32_16x16x32_bf16 v[16:19], v[72:75], v[20:23], v[16:19]
    s_or_b32 s27, s29, 0x8000
    s_waitcnt vmcnt(17)
    buffer_load_dwordx4 v[72:75], v1, s[16:19], s27 offen offset:0 nt
    v_and_b32_dpp v20, v50, v28 row_newbcast:9 row_mask:0xf bank_mask:0xf
    v_and_b32_dpp v21, v50, v29 row_newbcast:9 row_mask:0xf bank_mask:0xf
    v_and_b32_dpp v22, v50, v30 row_newbcast:9 row_mask:0xf bank_mask:0xf
    v_and_b32_dpp v23, v50, v31 row_newbcast:9 row_mask:0xf bank_mask:0xf
    v_mfma_f32_16x16x32_bf16 v[16:19], v[76:79], v[24:27], v[16:19]
    s_waitcnt vmcnt(16)
    buffer_load_dwordx4 v[76:79], v1, s[16:19], s27 offen offset:1024 nt
    v_and_b32_dpp v24, v50, v28 row_newbcast:13 row_mask:0xf bank_mask:0xf
    v_and_b32_dpp v25, v50, v29 row_newbcast:13 row_mask:0xf bank_mask:0xf
    v_and_b32_dpp v26, v50, v30 row_newbcast:13 row_mask:0xf bank_mask:0xf
    v_and_b32_dpp v27, v50, v31 row_newbcast:13 row_mask:0xf bank_mask:0xf
    v_mfma_f32_16x16x32_bf16 v[16:19], v[80:83], v[20:23], v[16:19]
    s_waitcnt vmcnt(17)
    buffer_load_dwordx4 v[80:83], v1, s[16:19], s27 offen offset:2048 nt
    v_mfma_f32_16x16x32_bf16 v[16:19], v[84:87], v[24:27], v[16:19]
    s_waitcnt vmcnt(16)
    buffer_load_dwordx4 v[84:87], v1, s[16:19], s27 offen offset:3072 nt
    v_and_b32_dpp v20, v50, v28 row_newbcast:2 row_mask:0xf bank_mask:0xf
    v_and_b32_dpp v21, v50, v29 row_newbcast:2 row_mask:0xf bank_mask:0xf
    v_and_b32_dpp v22, v50, v30 row_newbcast:2 row_mask:0xf bank_mask:0xf
    v_and_b32_dpp v23, v50, v31 row_newbcast:2 row_mask:0xf bank_mask:0xf
    v_and_b32_dpp v24, v50, v28 row_newbcast:6 row_mask:0xf bank_mask:0xf
    v_and_b32_dpp v25, v50, v29 row_newbcast:6 row_mask:0xf bank_mask:0xf
    v_and_b32_dpp v26, v50, v30 row_newbcast:6 row_mask:0xf bank_mask:0xf
    v_and_b32_dpp v27, v50, v31 row_newbcast:6 row_mask:0xf bank_mask:0xf
    s_waitcnt vmcnt(28)
    v_mfma_f32_16x16x32_bf16 v[16:19], v[88:91], v[20:23], v[16:19]
    s_or_b32 s27, s29, 0x1000
    s_waitcnt vmcnt(17)
    buffer_load_dwordx4 v[88:91], v1, s[16:19], s27 offen offset:0 nt
    v_and_b32_dpp v20, v50, v28 row_newbcast:10 row_mask:0xf bank_mask:0xf
    v_and_b32_dpp v21, v50, v29 row_newbcast:10 row_mask:0xf bank_mask:0xf
    v_and_b32_dpp v22, v50, v30 row_newbcast:10 row_mask:0xf bank_mask:0xf
    v_and_b32_dpp v23, v50, v31 row_newbcast:10 row_mask:0xf bank_mask:0xf
    v_mfma_f32_16x16x32_bf16 v[16:19], v[92:95], v[24:27], v[16:19]
    s_waitcnt vmcnt(16)
    buffer_load_dwordx4 v[92:95], v1, s[16:19], s27 offen offset:1024 nt
    v_and_b32_dpp v24, v50, v28 row_newbcast:14 row_mask:0xf bank_mask:0xf
    v_and_b32_dpp v25, v50, v29 row_newbcast:14 row_mask:0xf bank_mask:0xf
    v_and_b32_dpp v26, v50, v30 row_newbcast:14 row_mask:0xf bank_mask:0xf
    v_and_b32_dpp v27, v50, v31 row_newbcast:14 row_mask:0xf bank_mask:0xf
    v_mfma_f32_16x16x32_bf16 v[16:19], v[96:99], v[20:23], v[16:19]
    s_waitcnt vmcnt(17)
    buffer_load_dwordx4 v[96:99], v1, s[16:19], s27 offen offset:2048 nt
    v_mfma_f32_16x16x32_bf16 v[16:19], v[100:103], v[24:27], v[16:19]
    s_waitcnt vmcnt(16)
    buffer_load_dwordx4 v[100:103], v1, s[16:19], s27 offen offset:3072 nt
    v_and_b32_dpp v20, v50, v28 row_newbcast:3 row_mask:0xf bank_mask:0xf
    v_and_b32_dpp v21, v50, v29 row_newbcast:3 row_mask:0xf bank_mask:0xf
    v_and_b32_dpp v22, v50, v30 row_newbcast:3 row_mask:0xf bank_mask:0xf
    v_and_b32_dpp v23, v50, v31 row_newbcast:3 row_mask:0xf bank_mask:0xf
    v_and_b32_dpp v24, v50, v28 row_newbcast:7 row_mask:0xf bank_mask:0xf
    v_and_b32_dpp v25, v50, v29 row_newbcast:7 row_mask:0xf bank_mask:0xf
    v_and_b32_dpp v26, v50, v30 row_newbcast:7 row_mask:0xf bank_mask:0xf
    v_and_b32_dpp v27, v50, v31 row_newbcast:7 row_mask:0xf bank_mask:0xf
    s_waitcnt vmcnt(28)
    v_mfma_f32_16x16x32_bf16 v[16:19], v[104:107], v[20:23], v[16:19]
    s_or_b32 s27, s29, 0x9000
    s_waitcnt vmcnt(17)
    buffer_load_dwordx4 v[104:107], v1, s[16:19], s27 offen offset:0 nt
    v_and_b32_dpp v20, v50, v28 row_newbcast:11 row_mask:0xf bank_mask:0xf
    v_and_b32_dpp v21, v50, v29 row_newbcast:11 row_mask:0xf bank_mask:0xf
    v_and_b32_dpp v22, v50, v30 row_newbcast:11 row_mask:0xf bank_mask:0xf
    v_and_b32_dpp v23, v50, v31 row_newbcast:11 row_mask:0xf bank_mask:0xf
    v_mfma_f32_16x16x32_bf16 v[16:19], v[108:111], v[24:27], v[16:19]
    s_waitcnt vmcnt(16)
    buffer_load_dwordx4 v[108:111], v1, s[16:19], s27 offen offset:1024 nt
    v_and_b32_dpp v24, v50, v28 row_newbcast:15 row_mask:0xf bank_mask:0xf
    v_and_b32_dpp v25, v50, v29 row_newbcast:15 row_mask:0xf bank_mask:0xf
    v_and_b32_dpp v26, v50, v30 row_newbcast:15 row_mask:0xf bank_mask:0xf
    v_and_b32_dpp v27, v50, v31 row_newbcast:15 row_mask:0xf bank_mask:0xf
    v_mfma_f32_16x16x32_bf16 v[16:19], v[112:115], v[20:23], v[16:19]
    s_waitcnt vmcnt(17)
    buffer_load_dwordx4 v[112:115], v1, s[16:19], s27 offen offset:2048 nt
    v_mfma_f32_16x16x32_bf16 v[16:19], v[116:119], v[24:27], v[16:19]
    s_waitcnt vmcnt(16)
    buffer_load_dwordx4 v[116:119], v1, s[16:19], s27 offen offset:3072 nt
    v_and_b32_dpp v20, v51, v28 row_newbcast:0 row_mask:0xf bank_mask:0xf
    v_and_b32_dpp v21, v51, v29 row_newbcast:0 row_mask:0xf bank_mask:0xf
    v_and_b32_dpp v22, v51, v30 row_newbcast:0 row_mask:0xf bank_mask:0xf
    v_and_b32_dpp v23, v51, v31 row_newbcast:0 row_mask:0xf bank_mask:0xf
    v_and_b32_dpp v24, v51, v28 row_newbcast:4 row_mask:0xf bank_mask:0xf
    v_and_b32_dpp v25, v51, v29 row_newbcast:4 row_mask:0xf bank_mask:0xf
    v_and_b32_dpp v26, v51, v30 row_newbcast:4 row_mask:0xf bank_mask:0xf
    v_and_b32_dpp v27, v51, v31 row_newbcast:4 row_mask:0xf bank_mask:0xf
    s_waitcnt vmcnt(28)
    v_mfma_f32_16x16x32_bf16 v[16:19], v[120:123], v[20:23], v[16:19]
    s_or_b32 s27, s29, 0x2000
    s_waitcnt vmcnt(17)
    buffer_load_dwordx4 v[120:123], v1, s[16:19], s27 offen offset:0 nt
    v_and_b32_dpp v20, v51, v28 row_newbcast:8 row_mask:0xf bank_mask:0xf
    v_and_b32_dpp v21, v51, v29 row_newbcast:8 row_mask:0xf bank_mask:0xf
    v_and_b32_dpp v22, v51, v30 row_newbcast:8 row_mask:0xf bank_mask:0xf
    v_and_b32_dpp v23, v51, v31 row_newbcast:8 row_mask:0xf bank_mask:0xf
    v_mfma_f32_16x16x32_bf16 v[16:19], v[124:127], v[24:27], v[16:19]
    s_waitcnt vmcnt(16)
    buffer_load_dwordx4 v[124:127], v1, s[16:19], s27 offen offset:1024 nt
    v_and_b32_dpp v24, v51, v28 row_newbcast:12 row_mask:0xf bank_mask:0xf
    v_and_b32_dpp v25, v51, v29 row_newbcast:12 row_mask:0xf bank_mask:0xf
    v_and_b32_dpp v26, v51, v30 row_newbcast:12 row_mask:0xf bank_mask:0xf
    v_and_b32_dpp v27, v51, v31 row_newbcast:12 row_mask:0xf bank_mask:0xf
    v_mfma_f32_16x16x32_bf16 v[16:19], v[128:131], v[20:23], v[16:19]
    s_waitcnt vmcnt(17)
    buffer_load_dwordx4 v[128:131], v1, s[16:19], s27 offen offset:2048 nt
    v_mfma_f32_16x16x32_bf16 v[16:19], v[132:135], v[24:27], v[16:19]
    s_waitcnt vmcnt(16)
    buffer_load_dwordx4 v[132:135], v1, s[16:19], s27 offen offset:3072 nt
    v_and_b32_dpp v20, v51, v28 row_newbcast:1 row_mask:0xf bank_mask:0xf
    v_and_b32_dpp v21, v51, v29 row_newbcast:1 row_mask:0xf bank_mask:0xf
    v_and_b32_dpp v22, v51, v30 row_newbcast:1 row_mask:0xf bank_mask:0xf
    v_and_b32_dpp v23, v51, v31 row_newbcast:1 row_mask:0xf bank_mask:0xf
    v_and_b32_dpp v24, v51, v28 row_newbcast:5 row_mask:0xf bank_mask:0xf
    v_and_b32_dpp v25, v51, v29 row_newbcast:5 row_mask:0xf bank_mask:0xf
    v_and_b32_dpp v26, v51, v30 row_newbcast:5 row_mask:0xf bank_mask:0xf
    v_and_b32_dpp v27, v51, v31 row_newbcast:5 row_mask:0xf bank_mask:0xf
    s_waitcnt vmcnt(28)
    v_mfma_f32_16x16x32_bf16 v[16:19], v[136:139], v[20:23], v[16:19]
    s_or_b32 s27, s29, 0xa000
    s_waitcnt vmcnt(17)
    buffer_load_dwordx4 v[136:139], v1, s[16:19], s27 offen offset:0 nt
    v_and_b32_dpp v20, v51, v28 row_newbcast:9 row_mask:0xf bank_mask:0xf
    v_and_b32_dpp v21, v51, v29 row_newbcast:9 row_mask:0xf bank_mask:0xf
    v_and_b32_dpp v22, v51, v30 row_newbcast:9 row_mask:0xf bank_mask:0xf
    v_and_b32_dpp v23, v51, v31 row_newbcast:9 row_mask:0xf bank_mask:0xf
    v_mfma_f32_16x16x32_bf16 v[16:19], v[140:143], v[24:27], v[16:19]
    s_waitcnt vmcnt(16)
    buffer_load_dwordx4 v[140:143], v1, s[16:19], s27 offen offset:1024 nt
    v_and_b32_dpp v24, v51, v28 row_newbcast:13 row_mask:0xf bank_mask:0xf
    v_and_b32_dpp v25, v51, v29 row_newbcast:13 row_mask:0xf bank_mask:0xf
    v_and_b32_dpp v26, v51, v30 row_newbcast:13 row_mask:0xf bank_mask:0xf
    v_and_b32_dpp v27, v51, v31 row_newbcast:13 row_mask:0xf bank_mask:0xf
    v_mfma_f32_16x16x32_bf16 v[16:19], v[144:147], v[20:23], v[16:19]
    s_waitcnt vmcnt(17)
    buffer_load_dwordx4 v[144:147], v1, s[16:19], s27 offen offset:2048 nt
    v_mfma_f32_16x16x32_bf16 v[16:19], v[148:151], v[24:27], v[16:19]
    s_waitcnt vmcnt(16)
    buffer_load_dwordx4 v[148:151], v1, s[16:19], s27 offen offset:3072 nt
    v_and_b32_dpp v20, v51, v28 row_newbcast:2 row_mask:0xf bank_mask:0xf
    v_and_b32_dpp v21, v51, v29 row_newbcast:2 row_mask:0xf bank_mask:0xf
    v_and_b32_dpp v22, v51, v30 row_newbcast:2 row_mask:0xf bank_mask:0xf
    v_and_b32_dpp v23, v51, v31 row_newbcast:2 row_mask:0xf bank_mask:0xf
    v_and_b32_dpp v24, v51, v28 row_newbcast:6 row_mask:0xf bank_mask:0xf
    v_and_b32_dpp v25, v51, v29 row_newbcast:6 row_mask:0xf bank_mask:0xf
    v_and_b32_dpp v26, v51, v30 row_newbcast:6 row_mask:0xf bank_mask:0xf
    v_and_b32_dpp v27, v51, v31 row_newbcast:6 row_mask:0xf bank_mask:0xf
    s_waitcnt vmcnt(28)
    v_mfma_f32_16x16x32_bf16 v[16:19], v[152:155], v[20:23], v[16:19]
    s_or_b32 s27, s29, 0x3000
    s_waitcnt vmcnt(17)
    buffer_load_dwordx4 v[152:155], v1, s[16:19], s27 offen offset:0 nt
    v_and_b32_dpp v20, v51, v28 row_newbcast:10 row_mask:0xf bank_mask:0xf
    v_and_b32_dpp v21, v51, v29 row_newbcast:10 row_mask:0xf bank_mask:0xf
    v_and_b32_dpp v22, v51, v30 row_newbcast:10 row_mask:0xf bank_mask:0xf
    v_and_b32_dpp v23, v51, v31 row_newbcast:10 row_mask:0xf bank_mask:0xf
    v_mfma_f32_16x16x32_bf16 v[16:19], v[156:159], v[24:27], v[16:19]
    s_waitcnt vmcnt(16)
    buffer_load_dwordx4 v[156:159], v1, s[16:19], s27 offen offset:1024 nt
    v_and_b32_dpp v24, v51, v28 row_newbcast:14 row_mask:0xf bank_mask:0xf
    v_and_b32_dpp v25, v51, v29 row_newbcast:14 row_mask:0xf bank_mask:0xf
    v_and_b32_dpp v26, v51, v30 row_newbcast:14 row_mask:0xf bank_mask:0xf
    v_and_b32_dpp v27, v51, v31 row_newbcast:14 row_mask:0xf bank_mask:0xf
    v_mfma_f32_16x16x32_bf16 v[16:19], v[160:163], v[20:23], v[16:19]
    s_waitcnt vmcnt(17)
    buffer_load_dwordx4 v[160:163], v1, s[16:19], s27 offen offset:2048 nt
    v_mfma_f32_16x16x32_bf16 v[16:19], v[164:167], v[24:27], v[16:19]
    s_waitcnt vmcnt(16)
    buffer_load_dwordx4 v[164:167], v1, s[16:19], s27 offen offset:3072 nt
    v_and_b32_dpp v20, v51, v28 row_newbcast:3 row_mask:0xf bank_mask:0xf
    v_and_b32_dpp v21, v51, v29 row_newbcast:3 row_mask:0xf bank_mask:0xf
    v_and_b32_dpp v22, v51, v30 row_newbcast:3 row_mask:0xf bank_mask:0xf
    v_and_b32_dpp v23, v51, v31 row_newbcast:3 row_mask:0xf bank_mask:0xf
    v_and_b32_dpp v24, v51, v28 row_newbcast:7 row_mask:0xf bank_mask:0xf
    v_and_b32_dpp v25, v51, v29 row_newbcast:7 row_mask:0xf bank_mask:0xf
    v_and_b32_dpp v26, v51, v30 row_newbcast:7 row_mask:0xf bank_mask:0xf
    v_and_b32_dpp v27, v51, v31 row_newbcast:7 row_mask:0xf bank_mask:0xf
    s_waitcnt vmcnt(28)
    v_mfma_f32_16x16x32_bf16 v[16:19], v[168:171], v[20:23], v[16:19]
    s_or_b32 s27, s29, 0xb000
    s_waitcnt vmcnt(17)
    buffer_load_dwordx4 v[168:171], v1, s[16:19], s27 offen offset:0 nt
    v_and_b32_dpp v20, v51, v28 row_newbcast:11 row_mask:0xf bank_mask:0xf
    v_and_b32_dpp v21, v51, v29 row_newbcast:11 row_mask:0xf bank_mask:0xf
    v_and_b32_dpp v22, v51, v30 row_newbcast:11 row_mask:0xf bank_mask:0xf
    v_and_b32_dpp v23, v51, v31 row_newbcast:11 row_mask:0xf bank_mask:0xf
    v_mfma_f32_16x16x32_bf16 v[16:19], v[172:175], v[24:27], v[16:19]
    s_waitcnt vmcnt(16)
    buffer_load_dwordx4 v[172:175], v1, s[16:19], s27 offen offset:1024 nt
    v_and_b32_dpp v24, v51, v28 row_newbcast:15 row_mask:0xf bank_mask:0xf
    v_and_b32_dpp v25, v51, v29 row_newbcast:15 row_mask:0xf bank_mask:0xf
    v_and_b32_dpp v26, v51, v30 row_newbcast:15 row_mask:0xf bank_mask:0xf
    v_and_b32_dpp v27, v51, v31 row_newbcast:15 row_mask:0xf bank_mask:0xf
    v_mfma_f32_16x16x32_bf16 v[16:19], v[176:179], v[20:23], v[16:19]
    s_waitcnt vmcnt(17)
    buffer_load_dwordx4 v[176:179], v1, s[16:19], s27 offen offset:2048 nt
    v_mfma_f32_16x16x32_bf16 v[16:19], v[180:183], v[24:27], v[16:19]
    s_waitcnt vmcnt(16)
    buffer_load_dwordx4 v[180:183], v1, s[16:19], s27 offen offset:3072 nt
    s_or_b32 s29, s29, 0xffe0bfff
    s_add_u32 s29, s29, 1
    s_and_b32 s29, s29, 0x1f4000
    s_sub_u32 s26, s26, 1
    s_cmp_lg_u32 s26, 0
    s_cbranch_scc1 L_loopV
    s_branch L_last
.p2align 3
L_V1:
    v_and_b32_dpp v20, v50, v28 row_newbcast:0 row_mask:0xf bank_mask:0xf
    v_and_b32_dpp v21, v50, v29 row_newbcast:0 row_mask:0xf bank_mask:0xf
    v_and_b32_dpp v22, v50, v30 row_newbcast:0 row_mask:0xf bank_mask:0xf
    v_and_b32_dpp v23, v50, v31 row_newbcast:0 row_mask:0xf bank_mask:0xf
    v_and_b32_dpp v24, v50, v28 row_newbcast:4 row_mask:0xf bank_mask:0xf
    v_and_b32_dpp v25, v50, v29 row_newbcast:4 row_mask:0xf bank_mask:0xf
    v_and_b32_dpp v26, v50, v30 row_newbcast:4 row_mask:0xf bank_mask:0xf
    v_and_b32_dpp v27, v50, v31 row_newbcast:4 row_mask:0xf bank_mask:0xf
    s_waitcnt vmcnt(28)
    v_mfma_f32_16x16x32_bf16 v[16:19], v[56:59], v[20:23], v[16:19]
    s_or_b32 s27, s29, 0x0
    s_waitcnt vmcnt(18)
    buffer_load_dwordx4 v[56:59], v1, s[16:19], s27 offen offset:0 nt
    v_and_b32_dpp v20, v50, v28 row_newbcast:8 row_mask:0xf bank_mask:0xf
    v_and_b32_dpp v21, v50, v29 row_newbcast:8 row_mask:0xf bank_mask:0xf
    v_and_b32_dpp v22, v50, v30 row_newbcast:8 row_mask:0xf bank_mask:0xf
    v_and_b32_dpp v23, v50, v31 row_newbcast:8 row_mask:0xf bank_mask:0xf
    v_mfma_f32_16x16x32_bf16 v[16:19], v[60:63], v[24:27], v[16:19]
    s_waitcnt vmcnt(18)
    buffer_load_dwordx4 v[60:63], v1, s[16:19], s27 offen offset:1024 nt
    v_and_b32_dpp v24, v50, v28 row_newbcast:12 row_mask:0xf bank_mask:0xf
    v_and_b32_dpp v25, v50, v29 row_newbcast:12 row_mask:0xf bank_mask:0xf
    v_and_b32_dpp v26, v50, v30 row_newbcast:12 row_mask:0xf bank_mask:0xf
    v_and_b32_dpp v27, v50, v31 row_newbcast:12 row_mask:0xf bank_mask:0xf
    v_mfma_f32_16x16x32_bf16 v[16:19], v[64:67], v[20:23], v[16:19]
    s_waitcnt vmcnt(18)
    buffer_load_dwordx4 v[64:67], v1, s[16:19], s27 offen offset:2048 nt
    v_mfma_f32_16x16x32_bf16 v[16:19], v[68:71], v[24:27], v[16:19]
    s_waitcnt vmcnt(18)
    buffer_load_dwordx4 v[68:71], v1, s[16:19], s27 offen offset:3072 nt
    v_and_b32_dpp v20, v50, v28 row_newbcast:1 row_mask:0xf bank_mask:0xf
    v_and_b32_dpp v21, v50, v29 row_newbcast:1 row_mask:0xf bank_mask:0xf
    v_and_b32_dpp v22, v50, v30 row_newbcast:1 row_mask:0xf bank_mask:0xf
    v_and_b32_dpp v23, v50, v31 row_newbcast:1 row_mask:0xf bank_mask:0xf
    v_and_b32_dpp v24, v50, v28 row_newbcast:5 row_mask:0xf bank_mask:0xf
    v_and_b32_dpp v25, v50, v29 row_newbcast:5 row_mask:0xf bank_mask:0xf
    v_and_b32_dpp v26, v50, v30 row_newbcast:5 row_mask:0xf bank_mask:0xf
    v_and_b32_dpp v27, v50, v31 row_newbcast:5 row_mask:0xf bank_mask:0xf
    s_waitcnt vmcnt(28)
    v_mfma_f32_16x16x32_bf16 v[16:19], v[72:75], v[20:23], v[16:19]
    s_or_b32 s27, s29, 0x8000
    s_waitcnt vmcnt(18)
    buffer_load_dwordx4 v[72:75], v1, s[16:19], s27 offen offset:0 nt
    v_and_b32_dpp v20, v50, v28 row_newbcast:9 row_mask:0xf bank_mask:0xf
    v_and_b32_dpp v21, v50, v29 row_newbcast:9 row_mask:0xf bank_mask:0xf
    v_and_b32_dpp v22, v50, v30 row_newbcast:9 row_mask:0xf bank_mask:0xf
    v_and_b32_dpp v23, v50, v31 row_newbcast:9 row_mask:0xf bank_mask:0xf
    v_mfma_f32_16x16x32_bf16 v[16:19], v[76:79], v[24:27], v[16:19]
    s_waitcnt vmcnt(18)
    buffer_load_dwordx4 v[76:79], v1, s[16:19], s27 offen offset:1024 nt
    v_and_b32_dpp v24, v50, v28 row_newbcast:13 row_mask:0xf bank_mask:0xf
    v_and_b32_dpp v25, v50, v29 row_newbcast:13 row_mask:0xf bank_mask:0xf
    v_and_b32_dpp v26, v50, v30 row_newbcast:13 row_mask:0xf bank_mask:0xf
    v_and_b32_dpp v27, v50, v31 row_newbcast:13 row_mask:0xf bank_mask:0xf
    v_mfma_f32_16x16x32_bf16 v[16:19], v[80:83], v[20:23], v[16:19]
    s_waitcnt vmcnt(18)
    buffer_load_dwordx4 v[80:83], v1, s[16:19], s27 offen offset:2048 nt
    v_mfma_f32_16x16x32_bf16 v[16:19], v[84:87], v[24:27], v[16:19]
    s_waitcnt vmcnt(18)
    buffer_load_dwordx4 v[84:87], v1, s[16:19], s27 offen offset:3072 nt
    v_and_b32_dpp v20, v50, v28 row_newbcast:2 row_mask:0xf bank_mask:0xf
    v_and_b32_dpp v21, v50, v29 row_newbcast:2 row_mask:0xf bank_mask:0xf
    v_and_b32_dpp v22, v50, v30 row_newbcast:2 row_mask:0xf bank_mask:0xf
    v_and_b32_dpp v23, v50, v31 row_newbcast:2 row_mask:0xf bank_mask:0xf
    v_and_b32_dpp v24, v50, v28 row_newbcast:6 row_mask:0xf bank_mask:0xf
    v_and_b32_dpp v25, v50, v29 row_newbcast:6 row_mask:0xf bank_mask:0xf
    v_and_b32_dpp v26, v50, v30 row_newbcast:6 row_mask:0xf bank_mask:0xf
    v_and_b32_dpp v27, v50, v31 row_newbcast:6 row_mask:0xf bank_mask:0xf
    s_waitcnt vmcnt(28)
    v_mfma_f32_16x16x32_bf16 v[16:19], v[88:91], v[20:23], v[16:19]
    s_or_b32 s27, s29, 0x1000
    s_waitcnt vmcnt(18)
    buffer_load_dwordx4 v[88:91], v1, s[16:19], s27 offen offset:0 nt
    v_and_b32_dpp v20, v50, v28 row_newbcast:10 row_mask:0xf bank_mask:0xf
    v_and_b32_dpp v21, v50, v29 row_newbcast:10 row_mask:0xf bank_mask:0xf
    v_and_b32_dpp v22, v50, v30 row_newbcast:10 row_mask:0xf bank_mask:0xf
    v_and_b32_dpp v23, v50, v31 row_newbcast:10 row_mask:0xf bank_mask:0xf
    v_mfma_f32_16x16x32_bf16 v[16:19], v[92:95], v[24:27], v[16:19]
    s_waitcnt vmcnt(18)
    buffer_load_dwordx4 v[92:95], v1, s[16:19], s27 offen offset:1024 nt
    v_and_b32_dpp v24, v50, v28 row_newbcast:14 row_mask:0xf bank_mask:0xf
    v_and_b32_dpp v25, v50, v29 row_newbcast:14 row_mask:0xf bank_mask:0xf
    v_and_b32_dpp v26, v50, v30 row_newbcast:14 row_mask:0xf bank_mask:0xf
    v_and_b32_dpp v27, v50, v31 row_newbcast:14 row_mask:0xf bank_mask:0xf
    v_mfma_f32_16x16x32_bf16 v[16:19], v[96:99], v[20:23], v[16:19]
    s_waitcnt vmcnt(18)
    buffer_load_dwordx4 v[96:99], v1, s[16:19], s27 offen offset:2048 nt
    v_mfma_f32_16x16x32_bf16 v[16:19], v[100:103], v[24:27], v[16:19]
    s_waitcnt vmcnt(18)
    buffer_load_dwordx4 v[100:103], v1, s[16:19], s27 offen offset:3072 nt
    v_and_b32_dpp v20, v50, v28 row_newbcast:3 row_mask:0xf bank_mask:0xf
    v_and_b32_dpp v21, v50, v29 row_newbcast:3 row_mask:0xf bank_mask:0xf
    v_and_b32_dpp v22, v50, v30 row_newbcast:3 row_mask:0xf bank_mask:0xf
    v_and_b32_dpp v23, v50, v31 row_newbcast:3 row_mask:0xf bank_mask:0xf
    v_and_b32_dpp v24, v50, v28 row_newbcast:7 row_mask:0xf bank_mask:0xf
    v_and_b32_dpp v25, v50, v29 row_newbcast:7 row_mask:0xf bank_mask:0xf
    v_and_b32_dpp v26, v50, v30 row_newbcast:7 row_mask:0xf bank_mask:0xf
    v_and_b32_dpp v27, v50, v31 row_newbcast:7 row_mask:0xf bank_mask:0xf
    s_waitcnt vmcnt(28)
    v_mfma_f32_16x16x32_bf16 v[16:19], v[104:107], v[20:23], v[16:19]
    s_or_b32 s27, s29, 0x9000
    s_waitcnt vmcnt(18)
    buffer_load_dwordx4 v[104:107], v1, s[16:19], s27 offen offset:0 nt
    v_and_b32_dpp v20, v50, v28 row_newbcast:11 row_mask:0xf bank_mask:0xf
    v_and_b32_dpp v21, v50, v29 row_newbcast:11 row_mask:0xf bank_mask:0xf
    v_and_b32_dpp v22, v50, v30 row_newbcast:11 row_mask:0xf bank_mask:0xf
    v_and_b32_dpp v23, v50, v31 row_newbcast:11 row_mask:0xf bank_mask:0xf
    v_mfma_f32_16x16x32_bf16 v[16:19], v[108:111], v[24:27], v[16:19]
    s_waitcnt vmcnt(18)
    buffer_load_dwordx4 v[108:111], v1, s[16:19], s27 offen offset:1024 nt
    v_and_b32_dpp v24, v50, v28 row_newbcast:15 row_mask:0xf bank_mask:0xf
    v_and_b32_dpp v25, v50, v29 row_newbcast:15 row_mask:0xf bank_mask:0xf
    v_and_b32_dpp v26, v50, v30 row_newbcast:15 row_mask:0xf bank_mask:0xf
    v_and_b32_dpp v27, v50, v31 row_newbcast:15 row_mask:0xf bank_mask:0xf
    v_mfma_f32_16x16x32_bf16 v[16:19], v[112:115], v[20:23], v[16:19]
    s_waitcnt vmcnt(18)
    buffer_load_dwordx4 v[112:115], v1, s[16:19], s27 offen offset:2048 nt
    v_mfma_f32_16x16x32_bf16 v[16:19], v[116:119], v[24:27], v[16:19]
    s_waitcnt vmcnt(18)
    buffer_load_dwordx4 v[116:119], v1, s[16:19], s27 offen offset:3072 nt
    v_and_b32_dpp v20, v51, v28 row_newbcast:0 row_mask:0xf bank_mask:0xf
    v_and_b32_dpp v21, v51, v29 row_newbcast:0 row_mask:0xf bank_mask:0xf
    v_and_b32_dpp v22, v51, v30 row_newbcast:0 row_mask:0xf bank_mask:0xf
    v_and_b32_dpp v23, v51, v31 row_newbcast:0 row_mask:0xf bank_mask:0xf
    v_and_b32_dpp v24, v51, v28 row_newbcast:4 row_mask:0xf bank_mask:0xf
    v_and_b32_dpp v25, v51, v29 row_newbcast:4 row_mask:0xf bank_mask:0xf
    v_and_b32_dpp v26, v51, v30 row_newbcast:4 row_mask:0xf bank_mask:0xf
    v_and_b32_dpp v27, v51, v31 row_newbcast:4 row_mask:0xf bank_mask:0xf
    s_waitcnt vmcnt(28)
    v_mfma_f32_16x16x32_bf16 v[16:19], v[120:123], v[20:23], v[16:19]
    s_or_b32 s27, s29, 0x2000
    s_waitcnt vmcnt(18)
    buffer_load_dwordx4 v[120:123], v1, s[16:19], s27 offen offset:0 nt
    v_and_b32_dpp v20, v51, v28 row_newbcast:8 row_mask:0xf bank_mask:0xf
    v_and_b32_dpp v21, v51, v29 row_newbcast:8 row_mask:0xf bank_mask:0xf
    v_and_b32_dpp v22, v51, v30 row_newbcast:8 row_mask:0xf bank_mask:0xf
    v_and_b32_dpp v23, v51, v31 row_newbcast:8 row_mask:0xf bank_mask:0xf
    v_mfma_f32_16x16x32_bf16 v[16:19], v[124:127], v[24:27], v[16:19]
    s_waitcnt vmcnt(18)
    buffer_load_dwordx4 v[124:127], v1, s[16:19], s27 offen offset:1024 nt
    v_and_b32_dpp v24, v51, v28 row_newbcast:12 row_mask:0xf bank_mask:0xf
    v_and_b32_dpp v25, v51, v29 row_newbcast:12 row_mask:0xf bank_mask:0xf
    v_and_b32_dpp v26, v51, v30 row_newbcast:12 row_mask:0xf bank_mask:0xf
    v_and_b32_dpp v27, v51, v31 row_newbcast:12 row_mask:0xf bank_mask:0xf
    v_mfma_f32_16x16x32_bf16 v[16:19], v[128:131], v[20:23], v[16:19]
    s_waitcnt vmcnt(18)
    buffer_load_dwordx4 v[128:131], v1, s[16:19], s27 offen offset:2048 nt
    v_mfma_f32_16x16x32_bf16 v[16:19], v[132:135], v[24:27], v[16:19]
    s_waitcnt vmcnt(18)
    buffer_load_dwordx4 v[132:135], v1, s[16:19], s27 offen offset:3072 nt
    v_and_b32_dpp v20, v51, v28 row_newbcast:1 row_mask:0xf bank_mask:0xf
    v_and_b32_dpp v21, v51, v29 row_newbcast:1 row_mask:0xf bank_mask:0xf
    v_and_b32_dpp v22, v51, v30 row_newbcast:1 row_mask:0xf bank_mask:0xf
    v_and_b32_dpp v23, v51, v31 row_newbcast:1 row_mask:0xf bank_mask:0xf
    v_and_b32_dpp v24, v51, v28 row_newbcast:5 row_mask:0xf bank_mask:0xf
    v_and_b32_dpp v25, v51, v29 row_newbcast:5 row_mask:0xf bank_mask:0xf
    v_and_b32_dpp v26, v51, v30 row_newbcast:5 row_mask:0xf bank_mask:0xf
    v_and_b32_dpp v27, v51, v31 row_newbcast:5 row_mask:0xf bank_mask:0xf
    s_waitcnt vmcnt(28)
    v_mfma_f32_16x16x32_bf16 v[16:19], v[136:139], v[20:23], v[16:19]
    s_or_b32 s27, s29, 0xa000
    s_waitcnt vmcnt(18)
    buffer_load_dwordx4 v[136:139], v1, s[16:19], s27 offen offset:0 nt
    v_and_b32_dpp v20, v51, v28 row_newbcast:9 row_mask:0xf bank_mask:0xf
    v_and_b32_dpp v21, v51, v29 row_newbcast:9 row_mask:0xf bank_mask:0xf
    v_and_b32_dpp v22, v51, v30 row_newbcast:9 row_mask:0xf bank_mask:0xf
    v_and_b32_dpp v23, v51, v31 row_newbcast:9 row_mask:0xf bank_mask:0xf
    v_mfma_f32_16x16x32_bf16 v[16:19], v[140:143], v[24:27], v[16:19]
    s_waitcnt vmcnt(18)
    buffer_load_dwordx4 v[140:143], v1, s[16:19], s27 offen offset:1024 nt
    v_and_b32_dpp v24, v51, v28 row_newbcast:13 row_mask:0xf bank_mask:0xf
    v_and_b32_dpp v25, v51, v29 row_newbcast:13 row_mask:0xf bank_mask:0xf
    v_and_b32_dpp v26, v51, v30 row_newbcast:13 row_mask:0xf bank_mask:0xf
    v_and_b32_dpp v27, v51, v31 row_newbcast:13 row_mask:0xf bank_mask:0xf
    v_mfma_f32_16x16x32_bf16 v[16:19], v[144:147], v[20:23], v[16:19]
    s_waitcnt vmcnt(18)
    buffer_load_dwordx4 v[144:147], v1, s[16:19], s27 offen offset:2048 nt
    v_mfma_f32_16x16x32_bf16 v[16:19], v[148:151], v[24:27], v[16:19]
    s_waitcnt vmcnt(18)
    buffer_load_dwordx4 v[148:151], v1, s[16:19], s27 offen offset:3072 nt
    v_and_b32_dpp v20, v51, v28 row_newbcast:2 row_mask:0xf bank_mask:0xf
    v_and_b32_dpp v21, v51, v29 row_newbcast:2 row_mask:0xf bank_mask:0xf
    v_and_b32_dpp v22, v51, v30 row_newbcast:2 row_mask:0xf bank_mask:0xf
    v_and_b32_dpp v23, v51, v31 row_newbcast:2 row_mask:0xf bank_mask:0xf
    v_and_b32_dpp v24, v51, v28 row_newbcast:6 row_mask:0xf bank_mask:0xf
    v_and_b32_dpp v25, v51, v29 row_newbcast:6 row_mask:0xf bank_mask:0xf
    v_and_b32_dpp v26, v51, v30 row_newbcast:6 row_mask:0xf bank_mask:0xf
    v_and_b32_dpp v27, v51, v31 row_newbcast:6 row_mask:0xf bank_mask:0xf
    s_waitcnt vmcnt(28)
    v_mfma_f32_16x16x32_bf16 v[16:19], v[152:155], v[20:23], v[16:19]
    s_or_b32 s27, s29, 0x3000
    s_waitcnt vmcnt(18)
    buffer_load_dwordx4 v[152:155], v1, s[16:19], s27 offen offset:0 nt
    v_and_b32_dpp v20, v51, v28 row_newbcast:10 row_mask:0xf bank_mask:0xf
    v_and_b32_dpp v21, v51, v29 row_newbcast:10 row_mask:0xf bank_mask:0xf
    v_and_b32_dpp v22, v51, v30 row_newbcast:10 row_mask:0xf bank_mask:0xf
    v_and_b32_dpp v23, v51, v31 row_newbcast:10 row_mask:0xf bank_mask:0xf
    v_mfma_f32_16x16x32_bf16 v[16:19], v[156:159], v[24:27], v[16:19]
    s_waitcnt vmcnt(18)
    buffer_load_dwordx4 v[156:159], v1, s[16:19], s27 offen offset:1024 nt
    v_and_b32_dpp v24, v51, v28 row_newbcast:14 row_mask:0xf bank_mask:0xf
    v_and_b32_dpp v25, v51, v29 row_newbcast:14 row_mask:0xf bank_mask:0xf
    v_and_b32_dpp v26, v51, v30 row_newbcast:14 row_mask:0xf bank_mask:0xf
    v_and_b32_dpp v27, v51, v31 row_newbcast:14 row_mask:0xf bank_mask:0xf
    v_mfma_f32_16x16x32_bf16 v[16:19], v[160:163], v[20:23], v[16:19]
    s_waitcnt vmcnt(18)
    buffer_load_dwordx4 v[160:163], v1, s[16:19], s27 offen offset:2048 nt
    v_mfma_f32_16x16x32_bf16 v[16:19], v[164:167], v[24:27], v[16:19]
    s_waitcnt vmcnt(18)
    buffer_load_dwordx4 v[164:167], v1, s[16:19], s27 offen offset:3072 nt
    v_and_b32_dpp v20, v51, v28 row_newbcast:3 row_mask:0xf bank_mask:0xf
    v_and_b32_dpp v21, v51, v29 row_newbcast:3 row_mask:0xf bank_mask:0xf
    v_and_b32_dpp v22, v51, v30 row_newbcast:3 row_mask:0xf bank_mask:0xf
    v_and_b32_dpp v23, v51, v31 row_newbcast:3 row_mask:0xf bank_mask:0xf
    v_and_b32_dpp v24, v51, v28 row_newbcast:7 row_mask:0xf bank_mask:0xf
    v_and_b32_dpp v25, v51, v29 row_newbcast:7 row_mask:0xf bank_mask:0xf
    v_and_b32_dpp v26, v51, v30 row_newbcast:7 row_mask:0xf bank_mask:0xf
    v_and_b32_dpp v27, v51, v31 row_newbcast:7 row_mask:0xf bank_mask:0xf
    s_waitcnt vmcnt(28)
    v_mfma_f32_16x16x32_bf16 v[16:19], v[168:171], v[20:23], v[16:19]
    s_or_b32 s27, s29, 0xb000
    s_waitcnt vmcnt(18)
    buffer_load_dwordx4 v[168:171], v1, s[16:19], s27 offen offset:0 nt
    v_and_b32_dpp v20, v51, v28 row_newbcast:11 row_mask:0xf bank_mask:0xf
    v_and_b32_dpp v21, v51, v29 row_newbcast:11 row_mask:0xf bank_mask:0xf
    v_and_b32_dpp v22, v51, v30 row_newbcast:11 row_mask:0xf bank_mask:0xf
    v_and_b32_dpp v23, v51, v31 row_newbcast:11 row_mask:0xf bank_mask:0xf
    v_mfma_f32_16x16x32_bf16 v[16:19], v[172:175], v[24:27], v[16:19]
    s_waitcnt vmcnt(18)
    buffer_load_dwordx4 v[172:175], v1, s[16:19], s27 offen offset:1024 nt
    v_and_b32_dpp v24, v51, v28 row_newbcast:15 row_mask:0xf bank_mask:0xf
    v_and_b32_dpp v25, v51, v29 row_newbcast:15 row_mask:0xf bank_mask:0xf
    v_and_b32_dpp v26, v51, v30 row_newbcast:15 row_mask:0xf bank_mask:0xf
    v_and_b32_dpp v27, v51, v31 row_newbcast:15 row_mask:0xf bank_mask:0xf
    v_mfma_f32_16x16x32_bf16 v[16:19], v[176:179], v[20:23], v[16:19]
    s_waitcnt vmcnt(18)
    buffer_load_dwordx4 v[176:179], v1, s[16:19], s27 offen offset:2048 nt
    v_mfma_f32_16x16x32_bf16 v[16:19], v[180:183], v[24:27], v[16:19]
    s_waitcnt vmcnt(18)
    buffer_load_dwordx4 v[180:183], v1, s[16:19], s27 offen offset:3072 nt
    s_or_b32 s29, s29, 0xffe0bfff
    s_add_u32 s29, s29, 1
    s_and_b32 s29, s29, 0x1f4000
    s_sub_u32 s26, s26, 1
    s_cmp_lg_u32 s26, 0
    s_cbranch_scc1 L_loopV
    s_branch L_last
.p2align 3
L_V2:
    v_and_b32_dpp v20, v50, v28 row_newbcast:0 row_mask:0xf bank_mask:0xf
    v_and_b32_dpp v21, v50, v29 row_newbcast:0 row_mask:0xf bank_mask:0xf
    v_and_b32_dpp v22, v50, v30 row_newbcast:0 row_mask:0xf bank_mask:0xf
    v_and_b32_dpp v23, v50, v31 row_newbcast:0 row_mask:0xf bank_mask:0xf
    v_and_b32_dpp v24, v50, v28 row_newbcast:4 row_mask:0xf bank_mask:0xf
    v_and_b32_dpp v25, v50, v29 row_newbcast:4 row_mask:0xf bank_mask:0xf
    v_and_b32_dpp v26, v50, v30 row_newbcast:4 row_mask:0xf bank_mask:0xf
    v_and_b32_dpp v27, v50, v31 row_newbcast:4 row_mask:0xf bank_mask:0xf
    s_waitcnt vmcnt(28)
    v_mfma_f32_16x16x32_bf16 v[16:19], v[56:59], v[20:23], v[16:19]
    s_or_b32 s27, s29, 0x0
    s_waitcnt vmcnt(20)
    buffer_load_dwordx4 v[56:59], v1, s[16:19], s27 offen offset:0 nt
    v_and_b32_dpp v20, v50, v28 row_newbcast:8 row_mask:0xf bank_mask:0xf
    v_and_b32_dpp v21, v50, v29 row_newbcast:8 row_mask:0xf bank_mask:0xf
    v_and_b32_dpp v22, v50, v30 row_newbcast:8 row_mask:0xf bank_mask:0xf
    v_and_b32_dpp v23, v50, v31 row_newbcast:8 row_mask:0xf bank_mask:0xf
    v_mfma_f32_16x16x32_bf16 v[16:19], v[60:63], v[24:27], v[16:19]
    s_waitcnt vmcnt(19)
    buffer_load_dwordx4 v[60:63], v1, s[16:19], s27 offen offset:1024 nt
    v_and_b32_dpp v24, v50, v28 row_newbcast:12 row_mask:0xf bank_mask:0xf
    v_and_b32_dpp v25, v50, v29 row_newbcast:12 row_mask:0xf bank_mask:0xf
    v_and_b32_dpp v26, v50, v30 row_newbcast:12 row_mask:0xf bank_mask:0xf
    v_and_b32_dpp v27, v50, v31 row_newbcast:12 row_mask:0xf bank_mask:0xf
    v_mfma_f32_16x16x32_bf16 v[16:19], v[64:67], v[20:23], v[16:19]
    s_waitcnt vmcnt(20)
    buffer_load_dwordx4 v[64:67], v1, s[16:19], s27 offen offset:2048 nt
    v_mfma_f32_16x16x32_bf16 v[16:19], v[68:71], v[24:27], v[16:19]
    s_waitcnt vmcnt(19)
    buffer_load_dwordx4 v[68:71], v1, s[16:19], s27 offen offset:3072 nt
    v_and_b32_dpp v20, v50, v28 row_newbcast:1 row_mask:0xf bank_mask:0xf
    v_and_b32_dpp v21, v50, v29 row_newbcast:1 row_mask:0xf bank_mask:0xf
    v_and_b32_dpp v22, v50, v30 row_newbcast:1 row_mask:0xf bank_mask:0xf
    v_and_b32_dpp v23, v50, v31 row_newbcast:1 row_mask:0xf bank_mask:0xf
    v_and_b32_dpp v24, v50, v28 row_newbcast:5 row_mask:0xf bank_mask:0xf
    v_and_b32_dpp v25, v50, v29 row_newbcast:5 row_mask:0xf bank_mask:0xf
    v_and_b32_dpp v26, v50, v30 row_newbcast:5 row_mask:0xf bank_mask:0xf
    v_and_b32_dpp v27, v50, v31 row_newbcast:5 row_mask:0xf bank_mask:0xf
    s_waitcnt vmcnt(28)
    v_mfma_f32_16x16x32_bf16 v[16:19], v[72:75], v[20:23], v[16:19]
    s_or_b32 s27, s29, 0x8000
    s_waitcnt vmcnt(20)
    buffer_load_dwordx4 v[72:75], v1, s[16:19], s27 offen offset:0 nt
    v_and_b32_dpp v20, v50, v28 row_newbcast:9 row_mask:0xf bank_mask:0xf
    v_and_b32_dpp v21, v50, v29 row_newbcast:9 row_mask:0xf bank_mask:0xf
    v_and_b32_dpp v22, v50, v30 row_newbcast:9 row_mask:0xf bank_mask:0xf
    v_and_b32_dpp v23, v50, v31 row_newbcast:9 row_mask:0xf bank_mask:0xf
    v_mfma_f32_16x16x32_bf16 v[16:19], v[76:79], v[24:27], v[16:19]
    s_waitcnt vmcnt(19)
    buffer_load_dwordx4 v[76:79], v1, s[16:19], s27 offen offset:1024 nt
    v_and_b32_dpp v24, v50, v28 row_newbcast:13 row_mask:0xf bank_mask:0xf
    v_and_b32_dpp v25, v50, v29 row_newbcast:13 row_mask:0xf bank_mask:0xf
    v_and_b32_dpp v26, v50, v30 row_newbcast:13 row_mask:0xf bank_mask:0xf
    v_and_b32_dpp v27, v50, v31 row_newbcast:13 row_mask:0xf bank_mask:0xf
    v_mfma_f32_16x16x32_bf16 v[16:19], v[80:83], v[20:23], v[16:19]
    s_waitcnt vmcnt(20)
    buffer_load_dwordx4 v[80:83], v1, s[16:19], s27 offen offset:2048 nt
    v_mfma_f32_16x16x32_bf16 v[16:19], v[84:87], v[24:27], v[16:19]
    s_waitcnt vmcnt(19)
    buffer_load_dwordx4 v[84:87], v1, s[16:19], s27 offen offset:3072 nt
    v_and_b32_dpp v20, v50, v28 row_newbcast:2 row_mask:0xf bank_mask:0xf
    v_and_b32_dpp v21, v50, v29 row_newbcast:2 row_mask:0xf bank_mask:0xf
    v_and_b32_dpp v22, v50, v30 row_newbcast:2 row_mask:0xf bank_mask:0xf
    v_and_b32_dpp v23, v50, v31 row_newbcast:2 row_mask:0xf bank_mask:0xf
    v_and_b32_dpp v24, v50, v28 row_newbcast:6 row_mask:0xf bank_mask:0xf
    v_and_b32_dpp v25, v50, v29 row_newbcast:6 row_mask:0xf bank_mask:0xf
    v_and_b32_dpp v26, v50, v30 row_newbcast:6 row_mask:0xf bank_mask:0xf
    v_and_b32_dpp v27, v50, v31 row_newbcast:6 row_mask:0xf bank_mask:0xf
    s_waitcnt vmcnt(28)
    v_mfma_f32_16x16x32_bf16 v[16:19], v[88:91], v[20:23], v[16:19]
    s_or_b32 s27, s29, 0x1000
    s_waitcnt vmcnt(20)
    buffer_load_dwordx4 v[88:91], v1, s[16:19], s27 offen offset:0 nt
    v_and_b32_dpp v20, v50, v28 row_newbcast:10 row_mask:0xf bank_mask:0xf
    v_and_b32_dpp v21, v50, v29 row_newbcast:10 row_mask:0xf bank_mask:0xf
    v_and_b32_dpp v22, v50, v30 row_newbcast:10 row_mask:0xf bank_mask:0xf
    v_and_b32_dpp v23, v50, v31 row_newbcast:10 row_mask:0xf bank_mask:0xf
    v_mfma_f32_16x16x32_bf16 v[16:19], v[92:95], v[24:27], v[16:19]
    s_waitcnt vmcnt(19)
    buffer_load_dwordx4 v[92:95], v1, s[16:19], s27 offen offset:1024 nt
    v_and_b32_dpp v24, v50, v28 row_newbcast:14 row_mask:0xf bank_mask:0xf
    v_and_b32_dpp v25, v50, v29 row_newbcast:14 row_mask:0xf bank_mask:0xf
    v_and_b32_dpp v26, v50, v30 row_newbcast:14 row_mask:0xf bank_mask:0xf
    v_and_b32_dpp v27, v50, v31 row_newbcast:14 row_mask:0xf bank_mask:0xf
    v_mfma_f32_16x16x32_bf16 v[16:19], v[96:99], v[20:23], v[16:19]
    s_waitcnt vmcnt(20)
    buffer_load_dwordx4 v[96:99], v1, s[16:19], s27 offen offset:2048 nt
    v_mfma_f32_16x16x32_bf16 v[16:19], v[100:103], v[24:27], v[16:19]
    s_waitcnt vmcnt(19)
    buffer_load_dwordx4 v[100:103], v1, s[16:19], s27 offen offset:3072 nt
    v_and_b32_dpp v20, v50, v28 row_newbcast:3 row_mask:0xf bank_mask:0xf
    v_and_b32_dpp v21, v50, v29 row_newbcast:3 row_mask:0xf bank_mask:0xf
    v_and_b32_dpp v22, v50, v30 row_newbcast:3 row_mask:0xf bank_mask:0xf
    v_and_b32_dpp v23, v50, v31 row_newbcast:3 row_mask:0xf bank_mask:0xf
    v_and_b32_dpp v24, v50, v28 row_newbcast:7 row_mask:0xf bank_mask:0xf
    v_and_b32_dpp v25, v50, v29 row_newbcast:7 row_mask:0xf bank_mask:0xf
    v_and_b32_dpp v26, v50, v30 row_newbcast:7 row_mask:0xf bank_mask:0xf
    v_and_b32_dpp v27, v50, v31 row_newbcast:7 row_mask:0xf bank_mask:0xf
    s_waitcnt vmcnt(28)
    v_mfma_f32_16x16x32_bf16 v[16:19], v[104:107], v[20:23], v[16:19]
    s_or_b32 s27, s29, 0x9000
    s_waitcnt vmcnt(20)
    buffer_load_dwordx4 v[104:107], v1, s[16:19], s27 offen offset:0 nt
    v_and_b32_dpp v20, v50, v28 row_newbcast:11 row_mask:0xf bank_mask:0xf
    v_and_b32_dpp v21, v50, v29 row_newbcast:11 row_mask:0xf bank_mask:0xf
    v_and_b32_dpp v22, v50, v30 row_newbcast:11 row_mask:0xf bank_mask:0xf
    v_and_b32_dpp v23, v50, v31 row_newbcast:11 row_mask:0xf bank_mask:0xf
    v_mfma_f32_16x16x32_bf16 v[16:19], v[108:111], v[24:27], v[16:19]
    s_waitcnt vmcnt(19)
    buffer_load_dwordx4 v[108:111], v1, s[16:19], s27 offen offset:1024 nt
    v_and_b32_dpp v24, v50, v28 row_newbcast:15 row_mask:0xf bank_mask:0xf
    v_and_b32_dpp v25, v50, v29 row_newbcast:15 row_mask:0xf bank_mask:0xf
    v_and_b32_dpp v26, v50, v30 row_newbcast:15 row_mask:0xf bank_mask:0xf
    v_and_b32_dpp v27, v50, v31 row_newbcast:15 row_mask:0xf bank_mask:0xf
    v_mfma_f32_16x16x32_bf16 v[16:19], v[112:115], v[20:23], v[16:19]
    s_waitcnt vmcnt(20)
    buffer_load_dwordx4 v[112:115], v1, s[16:19], s27 offen offset:2048 nt
    v_mfma_f32_16x16x32_bf16 v[16:19], v[116:119], v[24:27], v[16:19]
    s_waitcnt vmcnt(19)
    buffer_load_dwordx4 v[116:119], v1, s[16:19], s27 offen offset:3072 nt
    v_and_b32_dpp v20, v51, v28 row_newbcast:0 row_mask:0xf bank_mask:0xf
    v_and_b32_dpp v21, v51, v29 row_newbcast:0 row_mask:0xf bank_mask:0xf
    v_and_b32_dpp v22, v51, v30 row_newbcast:0 row_mask:0xf bank_mask:0xf
    v_and_b32_dpp v23, v51, v31 row_newbcast:0 row_mask:0xf bank_mask:0xf
    v_and_b32_dpp v24, v51, v28 row_newbcast:4 row_mask:0xf bank_mask:0xf
    v_and_b32_dpp v25, v51, v29 row_newbcast:4 row_mask:0xf bank_mask:0xf
    v_and_b32_dpp v26, v51, v30 row_newbcast:4 row_mask:0xf bank_mask:0xf
    v_and_b32_dpp v27, v51, v31 row_newbcast:4 row_mask:0xf bank_mask:0xf
    s_waitcnt vmcnt(28)
    v_mfma_f32_16x16x32_bf16 v[16:19], v[120:123], v[20:23], v[16:19]
    s_or_b32 s27, s29, 0x2000
    s_waitcnt vmcnt(20)
    buffer_load_dwordx4 v[120:123], v1, s[16:19], s27 offen offset:0 nt
    v_and_b32_dpp v20, v51, v28 row_newbcast:8 row_mask:0xf bank_mask:0xf
    v_and_b32_dpp v21, v51, v29 row_newbcast:8 row_mask:0xf bank_mask:0xf
    v_and_b32_dpp v22, v51, v30 row_newbcast:8 row_mask:0xf bank_mask:0xf
    v_and_b32_dpp v23, v51, v31 row_newbcast:8 row_mask:0xf bank_mask:0xf
    v_mfma_f32_16x16x32_bf16 v[16:19], v[124:127], v[24:27], v[16:19]
    s_waitcnt vmcnt(19)
    buffer_load_dwordx4 v[124:127], v1, s[16:19], s27 offen offset:1024 nt
    v_and_b32_dpp v24, v51, v28 row_newbcast:12 row_mask:0xf bank_mask:0xf
    v_and_b32_dpp v25, v51, v29 row_newbcast:12 row_mask:0xf bank_mask:0xf
    v_and_b32_dpp v26, v51, v30 row_newbcast:12 row_mask:0xf bank_mask:0xf
    v_and_b32_dpp v27, v51, v31 row_newbcast:12 row_mask:0xf bank_mask:0xf
    v_mfma_f32_16x16x32_bf16 v[16:19], v[128:131], v[20:23], v[16:19]
    s_waitcnt vmcnt(20)
    buffer_load_dwordx4 v[128:131], v1, s[16:19], s27 offen offset:2048 nt
    v_mfma_f32_16x16x32_bf16 v[16:19], v[132:135], v[24:27], v[16:19]
    s_waitcnt vmcnt(19)
    buffer_load_dwordx4 v[132:135], v1, s[16:19], s27 offen offset:3072 nt
    v_and_b32_dpp v20, v51, v28 row_newbcast:1 row_mask:0xf bank_mask:0xf
    v_and_b32_dpp v21, v51, v29 row_newbcast:1 row_mask:0xf bank_mask:0xf
    v_and_b32_dpp v22, v51, v30 row_newbcast:1 row_mask:0xf bank_mask:0xf
    v_and_b32_dpp v23, v51, v31 row_newbcast:1 row_mask:0xf bank_mask:0xf
    v_and_b32_dpp v24, v51, v28 row_newbcast:5 row_mask:0xf bank_mask:0xf
    v_and_b32_dpp v25, v51, v29 row_newbcast:5 row_mask:0xf bank_mask:0xf
    v_and_b32_dpp v26, v51, v30 row_newbcast:5 row_mask:0xf bank_mask:0xf
    v_and_b32_dpp v27, v51, v31 row_newbcast:5 row_mask:0xf bank_mask:0xf
    s_waitcnt vmcnt(28)
    v_mfma_f32_16x16x32_bf16 v[16:19], v[136:139], v[20:23], v[16:19]
    s_or_b32 s27, s29, 0xa000
    s_waitcnt vmcnt(20)
    buffer_load_dwordx4 v[136:139], v1, s[16:19], s27 offen offset:0 nt
    v_and_b32_dpp v20, v51, v28 row_newbcast:9 row_mask:0xf bank_mask:0xf
    v_and_b32_dpp v21, v51, v29 row_newbcast:9 row_mask:0xf bank_mask:0xf
    v_and_b32_dpp v22, v51, v30 row_newbcast:9 row_mask:0xf bank_mask:0xf
    v_and_b32_dpp v23, v51, v31 row_newbcast:9 row_mask:0xf bank_mask:0xf
    v_mfma_f32_16x16x32_bf16 v[16:19], v[140:143], v[24:27], v[16:19]
    s_waitcnt vmcnt(19)
    buffer_load_dwordx4 v[140:143], v1, s[16:19], s27 offen offset:1024 nt
    v_and_b32_dpp v24, v51, v28 row_newbcast:13 row_mask:0xf bank_mask:0xf
    v_and_b32_dpp v25, v51, v29 row_newbcast:13 row_mask:0xf bank_mask:0xf
    v_and_b32_dpp v26, v51, v30 row_newbcast:13 row_mask:0xf bank_mask:0xf
    v_and_b32_dpp v27, v51, v31 row_newbcast:13 row_mask:0xf bank_mask:0xf
    v_mfma_f32_16x16x32_bf16 v[16:19], v[144:147], v[20:23], v[16:19]
    s_waitcnt vmcnt(20)
    buffer_load_dwordx4 v[144:147], v1, s[16:19], s27 offen offset:2048 nt
    v_mfma_f32_16x16x32_bf16 v[16:19], v[148:151], v[24:27], v[16:19]
    s_waitcnt vmcnt(19)
    buffer_load_dwordx4 v[148:151], v1, s[16:19], s27 offen offset:3072 nt
    v_and_b32_dpp v20, v51, v28 row_newbcast:2 row_mask:0xf bank_mask:0xf
    v_and_b32_dpp v21, v51, v29 row_newbcast:2 row_mask:0xf bank_mask:0xf
    v_and_b32_dpp v22, v51, v30 row_newbcast:2 row_mask:0xf bank_mask:0xf
    v_and_b32_dpp v23, v51, v31 row_newbcast:2 row_mask:0xf bank_mask:0xf
    v_and_b32_dpp v24, v51, v28 row_newbcast:6 row_mask:0xf bank_mask:0xf
    v_and_b32_dpp v25, v51, v29 row_newbcast:6 row_mask:0xf bank_mask:0xf
    v_and_b32_dpp v26, v51, v30 row_newbcast:6 row_mask:0xf bank_mask:0xf
    v_and_b32_dpp v27, v51, v31 row_newbcast:6 row_mask:0xf bank_mask:0xf
    s_waitcnt vmcnt(28)
    v_mfma_f32_16x16x32_bf16 v[16:19], v[152:155], v[20:23], v[16:19]
    s_or_b32 s27, s29, 0x3000
    s_waitcnt vmcnt(20)
    buffer_load_dwordx4 v[152:155], v1, s[16:19], s27 offen offset:0 nt
    v_and_b32_dpp v20, v51, v28 row_newbcast:10 row_mask:0xf bank_mask:0xf
    v_and_b32_dpp v21, v51, v29 row_newbcast:10 row_mask:0xf bank_mask:0xf
    v_and_b32_dpp v22, v51, v30 row_newbcast:10 row_mask:0xf bank_mask:0xf
    v_and_b32_dpp v23, v51, v31 row_newbcast:10 row_mask:0xf bank_mask:0xf
    v_mfma_f32_16x16x32_bf16 v[16:19], v[156:159], v[24:27], v[16:19]
    s_waitcnt vmcnt(19)
    buffer_load_dwordx4 v[156:159], v1, s[16:19], s27 offen offset:1024 nt
    v_and_b32_dpp v24, v51, v28 row_newbcast:14 row_mask:0xf bank_mask:0xf
    v_and_b32_dpp v25, v51, v29 row_newbcast:14 row_mask:0xf bank_mask:0xf
    v_and_b32_dpp v26, v51, v30 row_newbcast:14 row_mask:0xf bank_mask:0xf
    v_and_b32_dpp v27, v51, v31 row_newbcast:14 row_mask:0xf bank_mask:0xf
    v_mfma_f32_16x16x32_bf16 v[16:19], v[160:163], v[20:23], v[16:19]
    s_waitcnt vmcnt(20)
    buffer_load_dwordx4 v[160:163], v1, s[16:19], s27 offen offset:2048 nt
    v_mfma_f32_16x16x32_bf16 v[16:19], v[164:167], v[24:27], v[16:19]
    s_waitcnt vmcnt(19)
    buffer_load_dwordx4 v[164:167], v1, s[16:19], s27 offen offset:3072 nt
    v_and_b32_dpp v20, v51, v28 row_newbcast:3 row_mask:0xf bank_mask:0xf
    v_and_b32_dpp v21, v51, v29 row_newbcast:3 row_mask:0xf bank_mask:0xf
    v_and_b32_dpp v22, v51, v30 row_newbcast:3 row_mask:0xf bank_mask:0xf
    v_and_b32_dpp v23, v51, v31 row_newbcast:3 row_mask:0xf bank_mask:0xf
    v_and_b32_dpp v24, v51, v28 row_newbcast:7 row_mask:0xf bank_mask:0xf
    v_and_b32_dpp v25, v51, v29 row_newbcast:7 row_mask:0xf bank_mask:0xf
    v_and_b32_dpp v26, v51, v30 row_newbcast:7 row_mask:0xf bank_mask:0xf
    v_and_b32_dpp v27, v51, v31 row_newbcast:7 row_mask:0xf bank_mask:0xf
    s_waitcnt vmcnt(28)
    v_mfma_f32_16x16x32_bf16 v[16:19], v[168:171], v[20:23], v[16:19]
    s_or_b32 s27, s29, 0xb000
    s_waitcnt vmcnt(20)
    buffer_load_dwordx4 v[168:171], v1, s[16:19], s27 offen offset:0 nt
    v_and_b32_dpp v20, v51, v28 row_newbcast:11 row_mask:0xf bank_mask:0xf
    v_and_b32_dpp v21, v51, v29 row_newbcast:11 row_mask:0xf bank_mask:0xf
    v_and_b32_dpp v22, v51, v30 row_newbcast:11 row_mask:0xf bank_mask:0xf
    v_and_b32_dpp v23, v51, v31 row_newbcast:11 row_mask:0xf bank_mask:0xf
    v_mfma_f32_16x16x32_bf16 v[16:19], v[172:175], v[24:27], v[16:19]
    s_waitcnt vmcnt(19)
    buffer_load_dwordx4 v[172:175], v1, s[16:19], s27 offen offset:1024 nt
    v_and_b32_dpp v24, v51, v28 row_newbcast:15 row_mask:0xf bank_mask:0xf
    v_and_b32_dpp v25, v51, v29 row_newbcast:15 row_mask:0xf bank_mask:0xf
    v_and_b32_dpp v26, v51, v30 row_newbcast:15 row_mask:0xf bank_mask:0xf
    v_and_b32_dpp v27, v51, v31 row_newbcast:15 row_mask:0xf bank_mask:0xf
    v_mfma_f32_16x16x32_bf16 v[16:19], v[176:179], v[20:23], v[16:19]
    s_waitcnt vmcnt(20)
    buffer_load_dwordx4 v[176:179], v1, s[16:19], s27 offen offset:2048 nt
    v_mfma_f32_16x16x32_bf16 v[16:19], v[180:183], v[24:27], v[16:19]
    s_waitcnt vmcnt(19)
    buffer_load_dwordx4 v[180:183], v1, s[16:19], s27 offen offset:3072 nt
    s_or_b32 s29, s29, 0xffe0bfff
    s_add_u32 s29, s29, 1
    s_and_b32 s29, s29, 0x1f4000
    s_sub_u32 s26, s26, 1
    s_cmp_lg_u32 s26, 0
    s_cbranch_scc1 L_loopV
    s_branch L_last
.p2align 3
L_V3:
    v_and_b32_dpp v20, v50, v28 row_newbcast:0 row_mask:0xf bank_mask:0xf
    v_and_b32_dpp v21, v50, v29 row_newbcast:0 row_mask:0xf bank_mask:0xf
    v_and_b32_dpp v22, v50, v30 row_newbcast:0 row_mask:0xf bank_mask:0xf
    v_and_b32_dpp v23, v50, v31 row_newbcast:0 row_mask:0xf bank_mask:0xf
    v_and_b32_dpp v24, v50, v28 row_newbcast:4 row_mask:0xf bank_mask:0xf
    v_and_b32_dpp v25, v50, v29 row_newbcast:4 row_mask:0xf bank_mask:0xf
    v_and_b32_dpp v26, v50, v30 row_newbcast:4 row_mask:0xf bank_mask:0xf
    v_and_b32_dpp v27, v50, v31 row_newbcast:4 row_mask:0xf bank_mask:0xf
    s_waitcnt vmcnt(28)
    v_mfma_f32_16x16x32_bf16 v[16:19], v[56:59], v[20:23], v[16:19]
    s_or_b32 s27, s29, 0x0
    s_waitcnt vmcnt(21)
    buffer_load_dwordx4 v[56:59], v1, s[16:19], s27 offen offset:0 nt
    v_and_b32_dpp v20, v50, v28 row_newbcast:8 row_mask:0xf bank_mask:0xf
    v_and_b32_dpp v21, v50, v29 row_newbcast:8 row_mask:0xf bank_mask:0xf
    v_and_b32_dpp v22, v50, v30 row_newbcast:8 row_mask:0xf bank_mask:0xf
    v_and_b32_dpp v23, v50, v31 row_newbcast:8 row_mask:0xf bank_mask:0xf
    v_mfma_f32_16x16x32_bf16 v[16:19], v[60:63], v[24:27], v[16:19]
    s_waitcnt vmcnt(21)
    buffer_load_dwordx4 v[60:63], v1, s[16:19], s27 offen offset:1024 nt
    v_and_b32_dpp v24, v50, v28 row_newbcast:12 row_mask:0xf bank_mask:0xf
    v_and_b32_dpp v25, v50, v29 row_newbcast:12 row_mask:0xf bank_mask:0xf
    v_and_b32_dpp v26, v50, v30 row_newbcast:12 row_mask:0xf bank_mask:0xf
    v_and_b32_dpp v27, v50, v31 row_newbcast:12 row_mask:0xf bank_mask:0xf
    v_mfma_f32_16x16x32_bf16 v[16:19], v[64:67], v[20:23], v[16:19]
    s_waitcnt vmcnt(21)
    buffer_load_dwordx4 v[64:67], v1, s[16:19], s27 offen offset:2048 nt
    v_mfma_f32_16x16x32_bf16 v[16:19], v[68:71], v[24:27], v[16:19]
    s_waitcnt vmcnt(21)
    buffer_load_dwordx4 v[68:71], v1, s[16:19], s27 offen offset:3072 nt
    v_and_b32_dpp v20, v50, v28 row_newbcast:1 row_mask:0xf bank_mask:0xf
    v_and_b32_dpp v21, v50, v29 row_newbcast:1 row_mask:0xf bank_mask:0xf
    v_and_b32_dpp v22, v50, v30 row_newbcast:1 row_mask:0xf bank_mask:0xf
    v_and_b32_dpp v23, v50, v31 row_newbcast:1 row_mask:0xf bank_mask:0xf
    v_and_b32_dpp v24, v50, v28 row_newbcast:5 row_mask:0xf bank_mask:0xf
    v_and_b32_dpp v25, v50, v29 row_newbcast:5 row_mask:0xf bank_mask:0xf
    v_and_b32_dpp v26, v50, v30 row_newbcast:5 row_mask:0xf bank_mask:0xf
    v_and_b32_dpp v27, v50, v31 row_newbcast:5 row_mask:0xf bank_mask:0xf
    s_waitcnt vmcnt(28)
    v_mfma_f32_16x16x32_bf16 v[16:19], v[72:75], v[20:23], v[16:19]
    s_or_b32 s27, s29, 0x8000
    s_waitcnt vmcnt(21)
    buffer_load_dwordx4 v[72:75], v1, s[16:19], s27 offen offset:0 nt
    v_and_b32_dpp v20, v50, v28 row_newbcast:9 row_mask:0xf bank_mask:0xf
    v_and_b32_dpp v21, v50, v29 row_newbcast:9 row_mask:0xf bank_mask:0xf
    v_and_b32_dpp v22, v50, v30 row_newbcast:9 row_mask:0xf bank_mask:0xf
    v_and_b32_dpp v23, v50, v31 row_newbcast:9 row_mask:0xf bank_mask:0xf
    v_mfma_f32_16x16x32_bf16 v[16:19], v[76:79], v[24:27], v[16:19]
    s_waitcnt vmcnt(21)
    buffer_load_dwordx4 v[76:79], v1, s[16:19], s27 offen offset:1024 nt
    v_and_b32_dpp v24, v50, v28 row_newbcast:13 row_mask:0xf bank_mask:0xf
    v_and_b32_dpp v25, v50, v29 row_newbcast:13 row_mask:0xf bank_mask:0xf
    v_and_b32_dpp v26, v50, v30 row_newbcast:13 row_mask:0xf bank_mask:0xf
    v_and_b32_dpp v27, v50, v31 row_newbcast:13 row_mask:0xf bank_mask:0xf
    v_mfma_f32_16x16x32_bf16 v[16:19], v[80:83], v[20:23], v[16:19]
    s_waitcnt vmcnt(21)
    buffer_load_dwordx4 v[80:83], v1, s[16:19], s27 offen offset:2048 nt
    v_mfma_f32_16x16x32_bf16 v[16:19], v[84:87], v[24:27], v[16:19]
    s_waitcnt vmcnt(21)
    buffer_load_dwordx4 v[84:87], v1, s[16:19], s27 offen offset:3072 nt
    v_and_b32_dpp v20, v50, v28 row_newbcast:2 row_mask:0xf bank_mask:0xf
    v_and_b32_dpp v21, v50, v29 row_newbcast:2 row_mask:0xf bank_mask:0xf
    v_and_b32_dpp v22, v50, v30 row_newbcast:2 row_mask:0xf bank_mask:0xf
    v_and_b32_dpp v23, v50, v31 row_newbcast:2 row_mask:0xf bank_mask:0xf
    v_and_b32_dpp v24, v50, v28 row_newbcast:6 row_mask:0xf bank_mask:0xf
    v_and_b32_dpp v25, v50, v29 row_newbcast:6 row_mask:0xf bank_mask:0xf
    v_and_b32_dpp v26, v50, v30 row_newbcast:6 row_mask:0xf bank_mask:0xf
    v_and_b32_dpp v27, v50, v31 row_newbcast:6 row_mask:0xf bank_mask:0xf
    s_waitcnt vmcnt(28)
    v_mfma_f32_16x16x32_bf16 v[16:19], v[88:91], v[20:23], v[16:19]
    s_or_b32 s27, s29, 0x1000
    s_waitcnt vmcnt(21)
    buffer_load_dwordx4 v[88:91], v1, s[16:19], s27 offen offset:0 nt
    v_and_b32_dpp v20, v50, v28 row_newbcast:10 row_mask:0xf bank_mask:0xf
    v_and_b32_dpp v21, v50, v29 row_newbcast:10 row_mask:0xf bank_mask:0xf
    v_and_b32_dpp v22, v50, v30 row_newbcast:10 row_mask:0xf bank_mask:0xf
    v_and_b32_dpp v23, v50, v31 row_newbcast:10 row_mask:0xf bank_mask:0xf
    v_mfma_f32_16x16x32_bf16 v[16:19], v[92:95], v[24:27], v[16:19]
    s_waitcnt vmcnt(21)
    buffer_load_dwordx4 v[92:95], v1, s[16:19], s27 offen offset:1024 nt
    v_and_b32_dpp v24, v50, v28 row_newbcast:14 row_mask:0xf bank_mask:0xf
    v_and_b32_dpp v25, v50, v29 row_newbcast:14 row_mask:0xf bank_mask:0xf
    v_and_b32_dpp v26, v50, v30 row_newbcast:14 row_mask:0xf bank_mask:0xf
    v_and_b32_dpp v27, v50, v31 row_newbcast:14 row_mask:0xf bank_mask:0xf
    v_mfma_f32_16x16x32_bf16 v[16:19], v[96:99], v[20:23], v[16:19]
    s_waitcnt vmcnt(21)
    buffer_load_dwordx4 v[96:99], v1, s[16:19], s27 offen offset:2048 nt
    v_mfma_f32_16x16x32_bf16 v[16:19], v[100:103], v[24:27], v[16:19]
    s_waitcnt vmcnt(21)
    buffer_load_dwordx4 v[100:103], v1, s[16:19], s27 offen offset:3072 nt
    v_and_b32_dpp v20, v50, v28 row_newbcast:3 row_mask:0xf bank_mask:0xf
    v_and_b32_dpp v21, v50, v29 row_newbcast:3 row_mask:0xf bank_mask:0xf
    v_and_b32_dpp v22, v50, v30 row_newbcast:3 row_mask:0xf bank_mask:0xf
    v_and_b32_dpp v23, v50, v31 row_newbcast:3 row_mask:0xf bank_mask:0xf
    v_and_b32_dpp v24, v50, v28 row_newbcast:7 row_mask:0xf bank_mask:0xf
    v_and_b32_dpp v25, v50, v29 row_newbcast:7 row_mask:0xf bank_mask:0xf
    v_and_b32_dpp v26, v50, v30 row_newbcast:7 row_mask:0xf bank_mask:0xf
    v_and_b32_dpp v27, v50, v31 row_newbcast:7 row_mask:0xf bank_mask:0xf
    s_waitcnt vmcnt(28)
    v_mfma_f32_16x16x32_bf16 v[16:19], v[104:107], v[20:23], v[16:19]
    s_or_b32 s27, s29, 0x9000
    s_waitcnt vmcnt(21)
    buffer_load_dwordx4 v[104:107], v1, s[16:19], s27 offen offset:0 nt
    v_and_b32_dpp v20, v50, v28 row_newbcast:11 row_mask:0xf bank_mask:0xf
    v_and_b32_dpp v21, v50, v29 row_newbcast:11 row_mask:0xf bank_mask:0xf
    v_and_b32_dpp v22, v50, v30 row_newbcast:11 row_mask:0xf bank_mask:0xf
    v_and_b32_dpp v23, v50, v31 row_newbcast:11 row_mask:0xf bank_mask:0xf
    v_mfma_f32_16x16x32_bf16 v[16:19], v[108:111], v[24:27], v[16:19]
    s_waitcnt vmcnt(21)
    buffer_load_dwordx4 v[108:111], v1, s[16:19], s27 offen offset:1024 nt
    v_and_b32_dpp v24, v50, v28 row_newbcast:15 row_mask:0xf bank_mask:0xf
    v_and_b32_dpp v25, v50, v29 row_newbcast:15 row_mask:0xf bank_mask:0xf
    v_and_b32_dpp v26, v50, v30 row_newbcast:15 row_mask:0xf bank_mask:0xf
    v_and_b32_dpp v27, v50, v31 row_newbcast:15 row_mask:0xf bank_mask:0xf
    v_mfma_f32_16x16x32_bf16 v[16:19], v[112:115], v[20:23], v[16:19]
    s_waitcnt vmcnt(21)
    buffer_load_dwordx4 v[112:115], v1, s[16:19], s27 offen offset:2048 nt
    v_mfma_f32_16x16x32_bf16 v[16:19], v[116:119], v[24:27], v[16:19]
    s_waitcnt vmcnt(21)
    buffer_load_dwordx4 v[116:119], v1, s[16:19], s27 offen offset:3072 nt
    v_and_b32_dpp v20, v51, v28 row_newbcast:0 row_mask:0xf bank_mask:0xf
    v_and_b32_dpp v21, v51, v29 row_newbcast:0 row_mask:0xf bank_mask:0xf
    v_and_b32_dpp v22, v51, v30 row_newbcast:0 row_mask:0xf bank_mask:0xf
    v_and_b32_dpp v23, v51, v31 row_newbcast:0 row_mask:0xf bank_mask:0xf
    v_and_b32_dpp v24, v51, v28 row_newbcast:4 row_mask:0xf bank_mask:0xf
    v_and_b32_dpp v25, v51, v29 row_newbcast:4 row_mask:0xf bank_mask:0xf
    v_and_b32_dpp v26, v51, v30 row_newbcast:4 row_mask:0xf bank_mask:0xf
    v_and_b32_dpp v27, v51, v31 row_newbcast:4 row_mask:0xf bank_mask:0xf
    s_waitcnt vmcnt(28)
    v_mfma_f32_16x16x32_bf16 v[16:19], v[120:123], v[20:23], v[16:19]
    s_or_b32 s27, s29, 0x2000
    s_waitcnt vmcnt(21)
    buffer_load_dwordx4 v[120:123], v1, s[16:19], s27 offen offset:0 nt
    v_and_b32_dpp v20, v51, v28 row_newbcast:8 row_mask:0xf bank_mask:0xf
    v_and_b32_dpp v21, v51, v29 row_newbcast:8 row_mask:0xf bank_mask:0xf
    v_and_b32_dpp v22, v51, v30 row_newbcast:8 row_mask:0xf bank_mask:0xf
    v_and_b32_dpp v23, v51, v31 row_newbcast:8 row_mask:0xf bank_mask:0xf
    v_mfma_f32_16x16x32_bf16 v[16:19], v[124:127], v[24:27], v[16:19]
    s_waitcnt vmcnt(21)
    buffer_load_dwordx4 v[124:127], v1, s[16:19], s27 offen offset:1024 nt
    v_and_b32_dpp v24, v51, v28 row_newbcast:12 row_mask:0xf bank_mask:0xf
    v_and_b32_dpp v25, v51, v29 row_newbcast:12 row_mask:0xf bank_mask:0xf
    v_and_b32_dpp v26, v51, v30 row_newbcast:12 row_mask:0xf bank_mask:0xf
    v_and_b32_dpp v27, v51, v31 row_newbcast:12 row_mask:0xf bank_mask:0xf
    v_mfma_f32_16x16x32_bf16 v[16:19], v[128:131], v[20:23], v[16:19]
    s_waitcnt vmcnt(21)
    buffer_load_dwordx4 v[128:131], v1, s[16:19], s27 offen offset:2048 nt
    v_mfma_f32_16x16x32_bf16 v[16:19], v[132:135], v[24:27], v[16:19]
    s_waitcnt vmcnt(21)
    buffer_load_dwordx4 v[132:135], v1, s[16:19], s27 offen offset:3072 nt
    v_and_b32_dpp v20, v51, v28 row_newbcast:1 row_mask:0xf bank_mask:0xf
    v_and_b32_dpp v21, v51, v29 row_newbcast:1 row_mask:0xf bank_mask:0xf
    v_and_b32_dpp v22, v51, v30 row_newbcast:1 row_mask:0xf bank_mask:0xf
    v_and_b32_dpp v23, v51, v31 row_newbcast:1 row_mask:0xf bank_mask:0xf
    v_and_b32_dpp v24, v51, v28 row_newbcast:5 row_mask:0xf bank_mask:0xf
    v_and_b32_dpp v25, v51, v29 row_newbcast:5 row_mask:0xf bank_mask:0xf
    v_and_b32_dpp v26, v51, v30 row_newbcast:5 row_mask:0xf bank_mask:0xf
    v_and_b32_dpp v27, v51, v31 row_newbcast:5 row_mask:0xf bank_mask:0xf
    s_waitcnt vmcnt(28)
    v_mfma_f32_16x16x32_bf16 v[16:19], v[136:139], v[20:23], v[16:19]
    s_or_b32 s27, s29, 0xa000
    s_waitcnt vmcnt(21)
    buffer_load_dwordx4 v[136:139], v1, s[16:19], s27 offen offset:0 nt
    v_and_b32_dpp v20, v51, v28 row_newbcast:9 row_mask:0xf bank_mask:0xf
    v_and_b32_dpp v21, v51, v29 row_newbcast:9 row_mask:0xf bank_mask:0xf
    v_and_b32_dpp v22, v51, v30 row_newbcast:9 row_mask:0xf bank_mask:0xf
    v_and_b32_dpp v23, v51, v31 row_newbcast:9 row_mask:0xf bank_mask:0xf
    v_mfma_f32_16x16x32_bf16 v[16:19], v[140:143], v[24:27], v[16:19]
    s_waitcnt vmcnt(21)
    buffer_load_dwordx4 v[140:143], v1, s[16:19], s27 offen offset:1024 nt
    v_and_b32_dpp v24, v51, v28 row_newbcast:13 row_mask:0xf bank_mask:0xf
    v_and_b32_dpp v25, v51, v29 row_newbcast:13 row_mask:0xf bank_mask:0xf
    v_and_b32_dpp v26, v51, v30 row_newbcast:13 row_mask:0xf bank_mask:0xf
    v_and_b32_dpp v27, v51, v31 row_newbcast:13 row_mask:0xf bank_mask:0xf
    v_mfma_f32_16x16x32_bf16 v[16:19], v[144:147], v[20:23], v[16:19]
    s_waitcnt vmcnt(21)
    buffer_load_dwordx4 v[144:147], v1, s[16:19], s27 offen offset:2048 nt
    v_mfma_f32_16x16x32_bf16 v[16:19], v[148:151], v[24:27], v[16:19]
    s_waitcnt vmcnt(21)
    buffer_load_dwordx4 v[148:151], v1, s[16:19], s27 offen offset:3072 nt
    v_and_b32_dpp v20, v51, v28 row_newbcast:2 row_mask:0xf bank_mask:0xf
    v_and_b32_dpp v21, v51, v29 row_newbcast:2 row_mask:0xf bank_mask:0xf
    v_and_b32_dpp v22, v51, v30 row_newbcast:2 row_mask:0xf bank_mask:0xf
    v_and_b32_dpp v23, v51, v31 row_newbcast:2 row_mask:0xf bank_mask:0xf
    v_and_b32_dpp v24, v51, v28 row_newbcast:6 row_mask:0xf bank_mask:0xf
    v_and_b32_dpp v25, v51, v29 row_newbcast:6 row_mask:0xf bank_mask:0xf
    v_and_b32_dpp v26, v51, v30 row_newbcast:6 row_mask:0xf bank_mask:0xf
    v_and_b32_dpp v27, v51, v31 row_newbcast:6 row_mask:0xf bank_mask:0xf
    s_waitcnt vmcnt(28)
    v_mfma_f32_16x16x32_bf16 v[16:19], v[152:155], v[20:23], v[16:19]
    s_or_b32 s27, s29, 0x3000
    s_waitcnt vmcnt(21)
    buffer_load_dwordx4 v[152:155], v1, s[16:19], s27 offen offset:0 nt
    v_and_b32_dpp v20, v51, v28 row_newbcast:10 row_mask:0xf bank_mask:0xf
    v_and_b32_dpp v21, v51, v29 row_newbcast:10 row_mask:0xf bank_mask:0xf
    v_and_b32_dpp v22, v51, v30 row_newbcast:10 row_mask:0xf bank_mask:0xf
    v_and_b32_dpp v23, v51, v31 row_newbcast:10 row_mask:0xf bank_mask:0xf
    v_mfma_f32_16x16x32_bf16 v[16:19], v[156:159], v[24:27], v[16:19]
    s_waitcnt vmcnt(21)
    buffer_load_dwordx4 v[156:159], v1, s[16:19], s27 offen offset:1024 nt
    v_and_b32_dpp v24, v51, v28 row_newbcast:14 row_mask:0xf bank_mask:0xf
    v_and_b32_dpp v25, v51, v29 row_newbcast:14 row_mask:0xf bank_mask:0xf
    v_and_b32_dpp v26, v51, v30 row_newbcast:14 row_mask:0xf bank_mask:0xf
    v_and_b32_dpp v27, v51, v31 row_newbcast:14 row_mask:0xf bank_mask:0xf
    v_mfma_f32_16x16x32_bf16 v[16:19], v[160:163], v[20:23], v[16:19]
    s_waitcnt vmcnt(21)
    buffer_load_dwordx4 v[160:163], v1, s[16:19], s27 offen offset:2048 nt
    v_mfma_f32_16x16x32_bf16 v[16:19], v[164:167], v[24:27], v[16:19]
    s_waitcnt vmcnt(21)
    buffer_load_dwordx4 v[164:167], v1, s[16:19], s27 offen offset:3072 nt
    v_and_b32_dpp v20, v51, v28 row_newbcast:3 row_mask:0xf bank_mask:0xf
    v_and_b32_dpp v21, v51, v29 row_newbcast:3 row_mask:0xf bank_mask:0xf
    v_and_b32_dpp v22, v51, v30 row_newbcast:3 row_mask:0xf bank_mask:0xf
    v_and_b32_dpp v23, v51, v31 row_newbcast:3 row_mask:0xf bank_mask:0xf
    v_and_b32_dpp v24, v51, v28 row_newbcast:7 row_mask:0xf bank_mask:0xf
    v_and_b32_dpp v25, v51, v29 row_newbcast:7 row_mask:0xf bank_mask:0xf
    v_and_b32_dpp v26, v51, v30 row_newbcast:7 row_mask:0xf bank_mask:0xf
    v_and_b32_dpp v27, v51, v31 row_newbcast:7 row_mask:0xf bank_mask:0xf
    s_waitcnt vmcnt(28)
    v_mfma_f32_16x16x32_bf16 v[16:19], v[168:171], v[20:23], v[16:19]
    s_or_b32 s27, s29, 0xb000
    s_waitcnt vmcnt(21)
    buffer_load_dwordx4 v[168:171], v1, s[16:19], s27 offen offset:0 nt
    v_and_b32_dpp v20, v51, v28 row_newbcast:11 row_mask:0xf bank_mask:0xf
    v_and_b32_dpp v21, v51, v29 row_newbcast:11 row_mask:0xf bank_mask:0xf
    v_and_b32_dpp v22, v51, v30 row_newbcast:11 row_mask:0xf bank_mask:0xf
    v_and_b32_dpp v23, v51, v31 row_newbcast:11 row_mask:0xf bank_mask:0xf
    v_mfma_f32_16x16x32_bf16 v[16:19], v[172:175], v[24:27], v[16:19]
    s_waitcnt vmcnt(21)
    buffer_load_dwordx4 v[172:175], v1, s[16:19], s27 offen offset:1024 nt
    v_and_b32_dpp v24, v51, v28 row_newbcast:15 row_mask:0xf bank_mask:0xf
    v_and_b32_dpp v25, v51, v29 row_newbcast:15 row_mask:0xf bank_mask:0xf
    v_and_b32_dpp v26, v51, v30 row_newbcast:15 row_mask:0xf bank_mask:0xf
    v_and_b32_dpp v27, v51, v31 row_newbcast:15 row_mask:0xf bank_mask:0xf
    v_mfma_f32_16x16x32_bf16 v[16:19], v[176:179], v[20:23], v[16:19]
    s_waitcnt vmcnt(21)
    buffer_load_dwordx4 v[176:179], v1, s[16:19], s27 offen offset:2048 nt
    v_mfma_f32_16x16x32_bf16 v[16:19], v[180:183], v[24:27], v[16:19]
    s_waitcnt vmcnt(21)
    buffer_load_dwordx4 v[180:183], v1, s[16:19], s27 offen offset:3072 nt
    s_or_b32 s29, s29, 0xffe0bfff
    s_add_u32 s29, s29, 1
    s_and_b32 s29, s29, 0x1f4000
    s_sub_u32 s26, s26, 1
    s_cmp_lg_u32 s26, 0
    s_cbranch_scc1 L_loopV
L_last:
    v_add_u32 v8, 512, v8
    s_waitcnt lgkmcnt(1)
    v_fma_f32 v6, v48, s30, -v4
    v_fma_f32 v7, v49, s30, -v4
    v_exp_f32 v6, v6
    v_exp_f32 v7, v7
    ds_read_b32 v48, v8
    ds_read_b32 v49, v8 offset:256
    ds_read_b32 v11, v8
    v_cvt_pk_bf16_f32 v50, v6, v6
    v_cvt_pk_bf16_f32 v51, v7, v7
    v_add_f32 v5, v5, v6
    v_add_f32 v5, v5, v7
    s_nop 1
    v_add_f32_dpp v5, v5, v5 row_ror:1 row_mask:0xf bank_mask:0xf
    s_nop 1
    v_add_f32_dpp v5, v5, v5 row_ror:2 row_mask:0xf bank_mask:0xf
    s_nop 1
    v_add_f32_dpp v5, v5, v5 row_ror:4 row_mask:0xf bank_mask:0xf
    s_nop 1
    v_add_f32_dpp v5, v5, v5 row_ror:8 row_mask:0xf bank_mask:0xf
    v_mov_b32 v9, v5
    s_nop 1
    v_permlane16_swap_b32 v5, v9
    s_nop 1
    v_add_f32 v5, v5, v9
    v_mov_b32 v9, v5
    s_nop 1
    v_permlane32_swap_b32 v5, v9
    s_nop 1
    v_add_f32 v5, v5, v9
    v_and_b32 v13, 15, v0
    v_lshrrev_b32 v14, 4, v0
    v_lshlrev_b32 v14, 6, v14
    v_lshlrev_b32 v13, 1, v13
    v_add_u32 v13, v13, v14
    s_lshl_b32 s28, 1, s38
    v_mov_b32 v7, s28
    v_mov_b32 v6, 0
    v_and_b32_dpp v20, v50, v28 row_newbcast:0 row_mask:0xf bank_mask:0xf
    v_and_b32_dpp v21, v50, v29 row_newbcast:0 row_mask:0xf bank_mask:0xf
    v_and_b32_dpp v22, v50, v30 row_newbcast:0 row_mask:0xf bank_mask:0xf
    v_and_b32_dpp v23, v50, v31 row_newbcast:0 row_mask:0xf bank_mask:0xf
    v_and_b32_dpp v24, v50, v28 row_newbcast:4 row_mask:0xf bank_mask:0xf
    v_and_b32_dpp v25, v50, v29 row_newbcast:4 row_mask:0xf bank_mask:0xf
    v_and_b32_dpp v26, v50, v30 row_newbcast:4 row_mask:0xf bank_mask:0xf
    v_and_b32_dpp v27, v50, v31 row_newbcast:4 row_mask:0xf bank_mask:0xf
    s_waitcnt vmcnt(28)
    v_mfma_f32_16x16x32_bf16 v[16:19], v[56:59], v[20:23], v[16:19]
    v_and_b32_dpp v20, v50, v28 row_newbcast:8 row_mask:0xf bank_mask:0xf
    v_and_b32_dpp v21, v50, v29 row_newbcast:8 row_mask:0xf bank_mask:0xf
    v_and_b32_dpp v22, v50, v30 row_newbcast:8 row_mask:0xf bank_mask:0xf
    v_and_b32_dpp v23, v50, v31 row_newbcast:8 row_mask:0xf bank_mask:0xf
    v_mfma_f32_16x16x32_bf16 v[16:19], v[60:63], v[24:27], v[16:19]
    v_and_b32_dpp v24, v50, v28 row_newbcast:12 row_mask:0xf bank_mask:0xf
    v_and_b32_dpp v25, v50, v29 row_newbcast:12 row_mask:0xf bank_mask:0xf
    v_and_b32_dpp v26, v50, v30 row_newbcast:12 row_mask:0xf bank_mask:0xf
    v_and_b32_dpp v27, v50, v31 row_newbcast:12 row_mask:0xf bank_mask:0xf
    v_mfma_f32_16x16x32_bf16 v[16:19], v[64:67], v[20:23], v[16:19]
    s_nop 0
    v_mfma_f32_16x16x32_bf16 v[16:19], v[68:71], v[24:27], v[16:19]
    v_and_b32_dpp v20, v50, v28 row_newbcast:1 row_mask:0xf bank_mask:0xf
    v_and_b32_dpp v21, v50, v29 row_newbcast:1 row_mask:0xf bank_mask:0xf
    v_and_b32_dpp v22, v50, v30 row_newbcast:1 row_mask:0xf bank_mask:0xf
    v_and_b32_dpp v23, v50, v31 row_newbcast:1 row_mask:0xf bank_mask:0xf
    v_and_b32_dpp v24, v50, v28 row_newbcast:5 row_mask:0xf bank_mask:0xf
    v_and_b32_dpp v25, v50, v29 row_newbcast:5 row_mask:0xf bank_mask:0xf
    v_and_b32_dpp v26, v50, v30 row_newbcast:5 row_mask:0xf bank_mask:0xf
    v_and_b32_dpp v27, v50, v31 row_newbcast:5 row_mask:0xf bank_mask:0xf
    s_waitcnt vmcnt(24)
    v_mfma_f32_16x16x32_bf16 v[16:19], v[72:75], v[20:23], v[16:19]
    v_and_b32_dpp v20, v50, v28 row_newbcast:9 row_mask:0xf bank_mask:0xf
    v_and_b32_dpp v21, v50, v29 row_newbcast:9 row_mask:0xf bank_mask:0xf
    v_and_b32_dpp v22, v50, v30 row_newbcast:9 row_mask:0xf bank_mask:0xf
    v_and_b32_dpp v23, v50, v31 row_newbcast:9 row_mask:0xf bank_mask:0xf
    v_mfma_f32_16x16x32_bf16 v[16:19], v[76:79], v[24:27], v[16:19]
    v_and_b32_dpp v24, v50, v28 row_newbcast:13 row_mask:0xf bank_mask:0xf
    v_and_b32_dpp v25, v50, v29 row_newbcast:13 row_mask:0xf bank_mask:0xf
    v_and_b32_dpp v26, v50, v30 row_newbcast:13 row_mask:0xf bank_mask:0xf
    v_and_b32_dpp v27, v50, v31 row_newbcast:13 row_mask:0xf bank_mask:0xf
    v_mfma_f32_16x16x32_bf16 v[16:19], v[80:83], v[20:23], v[16:19]
    s_nop 0
    v_mfma_f32_16x16x32_bf16 v[16:19], v[84:87], v[24:27], v[16:19]
    v_and_b32_dpp v20, v50, v28 row_newbcast:2 row_mask:0xf bank_mask:0xf
    v_and_b32_dpp v21, v50, v29 row_newbcast:2 row_mask:0xf bank_mask:0xf
    v_and_b32_dpp v22, v50, v30 row_newbcast:2 row_mask:0xf bank_mask:0xf
    v_and_b32_dpp v23, v50, v31 row_newbcast:2 row_mask:0xf bank_mask:0xf
    v_and_b32_dpp v24, v50, v28 row_newbcast:6 row_mask:0xf bank_mask:0xf
    v_and_b32_dpp v25, v50, v29 row_newbcast:6 row_mask:0xf bank_mask:0xf
    v_and_b32_dpp v26, v50, v30 row_newbcast:6 row_mask:0xf bank_mask:0xf
    v_and_b32_dpp v27, v50, v31 row_newbcast:6 row_mask:0xf bank_mask:0xf
    s_waitcnt vmcnt(20)
    v_mfma_f32_16x16x32_bf16 v[16:19], v[88:91], v[20:23], v[16:19]
    v_and_b32_dpp v20, v50, v28 row_newbcast:10 row_mask:0xf bank_mask:0xf
    v_and_b32_dpp v21, v50, v29 row_newbcast:10 row_mask:0xf bank_mask:0xf
    v_and_b32_dpp v22, v50, v30 row_newbcast:10 row_mask:0xf bank_mask:0xf
    v_and_b32_dpp v23, v50, v31 row_newbcast:10 row_mask:0xf bank_mask:0xf
    v_mfma_f32_16x16x32_bf16 v[16:19], v[92:95], v[24:27], v[16:19]
    v_and_b32_dpp v24, v50, v28 row_newbcast:14 row_mask:0xf bank_mask:0xf
    v_and_b32_dpp v25, v50, v29 row_newbcast:14 row_mask:0xf bank_mask:0xf
    v_and_b32_dpp v26, v50, v30 row_newbcast:14 row_mask:0xf bank_mask:0xf
    v_and_b32_dpp v27, v50, v31 row_newbcast:14 row_mask:0xf bank_mask:0xf
    v_mfma_f32_16x16x32_bf16 v[16:19], v[96:99], v[20:23], v[16:19]
    s_nop 0
    v_mfma_f32_16x16x32_bf16 v[16:19], v[100:103], v[24:27], v[16:19]
    v_and_b32_dpp v20, v50, v28 row_newbcast:3 row_mask:0xf bank_mask:0xf
    v_and_b32_dpp v21, v50, v29 row_newbcast:3 row_mask:0xf bank_mask:0xf
    v_and_b32_dpp v22, v50, v30 row_newbcast:3 row_mask:0xf bank_mask:0xf
    v_and_b32_dpp v23, v50, v31 row_newbcast:3 row_mask:0xf bank_mask:0xf
    v_and_b32_dpp v24, v50, v28 row_newbcast:7 row_mask:0xf bank_mask:0xf
    v_and_b32_dpp v25, v50, v29 row_newbcast:7 row_mask:0xf bank_mask:0xf
    v_and_b32_dpp v26, v50, v30 row_newbcast:7 row_mask:0xf bank_mask:0xf
    v_and_b32_dpp v27, v50, v31 row_newbcast:7 row_mask:0xf bank_mask:0xf
    s_waitcnt vmcnt(16)
    v_mfma_f32_16x16x32_bf16 v[16:19], v[104:107], v[20:23], v[16:19]
    v_and_b32_dpp v20, v50, v28 row_newbcast:11 row_mask:0xf bank_mask:0xf
    v_and_b32_dpp v21, v50, v29 row_newbcast:11 row_mask:0xf bank_mask:0xf
    v_and_b32_dpp v22, v50, v30 row_newbcast:11 row_mask:0xf bank_mask:0xf
    v_and_b32_dpp v23, v50, v31 row_newbcast:11 row_mask:0xf bank_mask:0xf
    v_mfma_f32_16x16x32_bf16 v[16:19], v[108:111], v[24:27], v[16:19]
    v_and_b32_dpp v24, v50, v28 row_newbcast:15 row_mask:0xf bank_mask:0xf
    v_and_b32_dpp v25, v50, v29 row_newbcast:15 row_mask:0xf bank_mask:0xf
    v_and_b32_dpp v26, v50, v30 row_newbcast:15 row_mask:0xf bank_mask:0xf
    v_and_b32_dpp v27, v50, v31 row_newbcast:15 row_mask:0xf bank_mask:0xf
    v_mfma_f32_16x16x32_bf16 v[16:19], v[112:115], v[20:23], v[16:19]
    s_nop 0
    v_mfma_f32_16x16x32_bf16 v[16:19], v[116:119], v[24:27], v[16:19]
    v_and_b32_dpp v20, v51, v28 row_newbcast:0 row_mask:0xf bank_mask:0xf
    v_and_b32_dpp v21, v51, v29 row_newbcast:0 row_mask:0xf bank_mask:0xf
    v_and_b32_dpp v22, v51, v30 row_newbcast:0 row_mask:0xf bank_mask:0xf
    v_and_b32_dpp v23, v51, v31 row_newbcast:0 row_mask:0xf bank_mask:0xf
    v_and_b32_dpp v24, v51, v28 row_newbcast:4 row_mask:0xf bank_mask:0xf
    v_and_b32_dpp v25, v51, v29 row_newbcast:4 row_mask:0xf bank_mask:0xf
    v_and_b32_dpp v26, v51, v30 row_newbcast:4 row_mask:0xf bank_mask:0xf
    v_and_b32_dpp v27, v51, v31 row_newbcast:4 row_mask:0xf bank_mask:0xf
    s_waitcnt vmcnt(12)
    v_mfma_f32_16x16x32_bf16 v[16:19], v[120:123], v[20:23], v[16:19]
    v_and_b32_dpp v20, v51, v28 row_newbcast:8 row_mask:0xf bank_mask:0xf
    v_and_b32_dpp v21, v51, v29 row_newbcast:8 row_mask:0xf bank_mask:0xf
    v_and_b32_dpp v22, v51, v30 row_newbcast:8 row_mask:0xf bank_mask:0xf
    v_and_b32_dpp v23, v51, v31 row_newbcast:8 row_mask:0xf bank_mask:0xf
    v_mfma_f32_16x16x32_bf16 v[16:19], v[124:127], v[24:27], v[16:19]
    v_and_b32_dpp v24, v51, v28 row_newbcast:12 row_mask:0xf bank_mask:0xf
    v_and_b32_dpp v25, v51, v29 row_newbcast:12 row_mask:0xf bank_mask:0xf
    v_and_b32_dpp v26, v51, v30 row_newbcast:12 row_mask:0xf bank_mask:0xf
    v_and_b32_dpp v27, v51, v31 row_newbcast:12 row_mask:0xf bank_mask:0xf
    v_mfma_f32_16x16x32_bf16 v[16:19], v[128:131], v[20:23], v[16:19]
    s_nop 0
    v_mfma_f32_16x16x32_bf16 v[16:19], v[132:135], v[24:27], v[16:19]
    v_and_b32_dpp v20, v51, v28 row_newbcast:1 row_mask:0xf bank_mask:0xf
    v_and_b32_dpp v21, v51, v29 row_newbcast:1 row_mask:0xf bank_mask:0xf
    v_and_b32_dpp v22, v51, v30 row_newbcast:1 row_mask:0xf bank_mask:0xf
    v_and_b32_dpp v23, v51, v31 row_newbcast:1 row_mask:0xf bank_mask:0xf
    v_and_b32_dpp v24, v51, v28 row_newbcast:5 row_mask:0xf bank_mask:0xf
    v_and_b32_dpp v25, v51, v29 row_newbcast:5 row_mask:0xf bank_mask:0xf
    v_and_b32_dpp v26, v51, v30 row_newbcast:5 row_mask:0xf bank_mask:0xf
    v_and_b32_dpp v27, v51, v31 row_newbcast:5 row_mask:0xf bank_mask:0xf
    s_waitcnt vmcnt(8)
    v_mfma_f32_16x16x32_bf16 v[16:19], v[136:139], v[20:23], v[16:19]
    v_and_b32_dpp v20, v51, v28 row_newbcast:9 row_mask:0xf bank_mask:0xf
    v_and_b32_dpp v21, v51, v29 row_newbcast:9 row_mask:0xf bank_mask:0xf
    v_and_b32_dpp v22, v51, v30 row_newbcast:9 row_mask:0xf bank_mask:0xf
    v_and_b32_dpp v23, v51, v31 row_newbcast:9 row_mask:0xf bank_mask:0xf
    v_mfma_f32_16x16x32_bf16 v[16:19], v[140:143], v[24:27], v[16:19]
    v_and_b32_dpp v24, v51, v28 row_newbcast:13 row_mask:0xf bank_mask:0xf
    v_and_b32_dpp v25, v51, v29 row_newbcast:13 row_mask:0xf bank_mask:0xf
    v_and_b32_dpp v26, v51, v30 row_newbcast:13 row_mask:0xf bank_mask:0xf
    v_and_b32_dpp v27, v51, v31 row_newbcast:13 row_mask:0xf bank_mask:0xf
    v_mfma_f32_16x16x32_bf16 v[16:19], v[144:147], v[20:23], v[16:19]
    s_nop 0
    v_mfma_f32_16x16x32_bf16 v[16:19], v[148:151], v[24:27], v[16:19]
    s_waitcnt lgkmcnt(0)
    global_load_dwordx4 v[52:55], v2, s[34:35] sc0 sc1
    s_lshr_b32 s31, s31, s38
    s_and_b32 s31, s31, 0xffff
    v_and_b32_dpp v20, v51, v28 row_newbcast:2 row_mask:0xf bank_mask:0xf
    v_and_b32_dpp v21, v51, v29 row_newbcast:2 row_mask:0xf bank_mask:0xf
    v_and_b32_dpp v22, v51, v30 row_newbcast:2 row_mask:0xf bank_mask:0xf
    v_and_b32_dpp v23, v51, v31 row_newbcast:2 row_mask:0xf bank_mask:0xf
    v_and_b32_dpp v24, v51, v28 row_newbcast:6 row_mask:0xf bank_mask:0xf
    v_and_b32_dpp v25, v51, v29 row_newbcast:6 row_mask:0xf bank_mask:0xf
    v_and_b32_dpp v26, v51, v30 row_newbcast:6 row_mask:0xf bank_mask:0xf
    v_and_b32_dpp v27, v51, v31 row_newbcast:6 row_mask:0xf bank_mask:0xf
    s_waitcnt vmcnt(5)
    v_mfma_f32_16x16x32_bf16 v[16:19], v[152:155], v[20:23], v[16:19]
    v_and_b32_dpp v20, v51, v28 row_newbcast:10 row_mask:0xf bank_mask:0xf
    v_and_b32_dpp v21, v51, v29 row_newbcast:10 row_mask:0xf bank_mask:0xf
    v_and_b32_dpp v22, v51, v30 row_newbcast:10 row_mask:0xf bank_mask:0xf
    v_and_b32_dpp v23, v51, v31 row_newbcast:10 row_mask:0xf bank_mask:0xf
    v_mfma_f32_16x16x32_bf16 v[16:19], v[156:159], v[24:27], v[16:19]
    v_and_b32_dpp v24, v51, v28 row_newbcast:14 row_mask:0xf bank_mask:0xf
    v_and_b32_dpp v25, v51, v29 row_newbcast:14 row_mask:0xf bank_mask:0xf
    v_and_b32_dpp v26, v51, v30 row_newbcast:14 row_mask:0xf bank_mask:0xf
    v_and_b32_dpp v27, v51, v31 row_newbcast:14 row_mask:0xf bank_mask:0xf
    v_mfma_f32_16x16x32_bf16 v[16:19], v[160:163], v[20:23], v[16:19]
    s_nop 0
    v_mfma_f32_16x16x32_bf16 v[16:19], v[164:167], v[24:27], v[16:19]
    v_and_b32_dpp v20, v51, v28 row_newbcast:3 row_mask:0xf bank_mask:0xf
    v_and_b32_dpp v21, v51, v29 row_newbcast:3 row_mask:0xf bank_mask:0xf
    v_and_b32_dpp v22, v51, v30 row_newbcast:3 row_mask:0xf bank_mask:0xf
    v_and_b32_dpp v23, v51, v31 row_newbcast:3 row_mask:0xf bank_mask:0xf
    v_and_b32_dpp v24, v51, v28 row_newbcast:7 row_mask:0xf bank_mask:0xf
    v_and_b32_dpp v25, v51, v29 row_newbcast:7 row_mask:0xf bank_mask:0xf
    v_and_b32_dpp v26, v51, v30 row_newbcast:7 row_mask:0xf bank_mask:0xf
    v_and_b32_dpp v27, v51, v31 row_newbcast:7 row_mask:0xf bank_mask:0xf
    s_waitcnt vmcnt(1)
    v_mfma_f32_16x16x32_bf16 v[16:19], v[168:171], v[20:23], v[16:19]
    v_and_b32_dpp v20, v51, v28 row_newbcast:11 row_mask:0xf bank_mask:0xf
    v_and_b32_dpp v21, v51, v29 row_newbcast:11 row_mask:0xf bank_mask:0xf
    v_and_b32_dpp v22, v51, v30 row_newbcast:11 row_mask:0xf bank_mask:0xf
    v_and_b32_dpp v23, v51, v31 row_newbcast:11 row_mask:0xf bank_mask:0xf
    v_mfma_f32_16x16x32_bf16 v[16:19], v[172:175], v[24:27], v[16:19]
    v_and_b32_dpp v24, v51, v28 row_newbcast:15 row_mask:0xf bank_mask:0xf
    v_and_b32_dpp v25, v51, v29 row_newbcast:15 row_mask:0xf bank_mask:0xf
    v_and_b32_dpp v26, v51, v30 row_newbcast:15 row_mask:0xf bank_mask:0xf
    v_and_b32_dpp v27, v51, v31 row_newbcast:15 row_mask:0xf bank_mask:0xf
    v_mfma_f32_16x16x32_bf16 v[16:19], v[176:179], v[20:23], v[16:19]
    s_nop 0
    v_mfma_f32_16x16x32_bf16 v[16:19], v[180:183], v[24:27], v[16:19]
    s_nop 7
    v_cndmask_b32 v20, v4, v16, s[40:41]
    v_cndmask_b32 v21, v5, v17, s[40:41]
    v_cndmask_b32 v22, v4, v18, s[40:41]
    v_cndmask_b32 v23, v5, v19, s[40:41]
    s_cmp_eq_u32 s31, 1
    s_cbranch_scc1 L_second
    v_min_u32 v20, -2, v20
    v_min_u32 v21, -2, v21
    v_min_u32 v22, -2, v22
    v_min_u32 v23, -2, v23
    global_store_dwordx4 v2, v[20:23], s[32:33] sc0 sc1
    s_branch L_exit
L_poll:
    global_load_dwordx4 v[52:55], v2, s[34:35] sc0 sc1
L_second:
    s_waitcnt vmcnt(0)
    v_max3_u32 v12, v52, v53, v54
    v_max_u32 v12, v12, v55
    v_cmp_eq_u32 vcc, -1, v12
    s_cbranch_vccnz L_poll
    v_max_f32 v12, v20, v52
    v_sub_f32 v14, v20, v12
    v_sub_f32 v15, v52, v12
    v_exp_f32 v14, v14
    v_exp_f32 v15, v15
    s_nop 1
    v_mul_f32_dpp v32, v14, v20 row_newbcast:8 row_mask:0xf bank_mask:0xf
    v_mul_f32_dpp v33, v14, v21 row_newbcast:8 row_mask:0xf bank_mask:0xf
    v_mul_f32_dpp v34, v14, v22 row_newbcast:8 row_mask:0xf bank_mask:0xf
    v_mul_f32_dpp v35, v14, v23 row_newbcast:8 row_mask:0xf bank_mask:0xf
    v_mul_f32_dpp v36, v15, v52 row_newbcast:8 row_mask:0xf bank_mask:0xf
    v_mul_f32_dpp v37, v15, v53 row_newbcast:8 row_mask:0xf bank_mask:0xf
    v_mul_f32_dpp v38, v15, v54 row_newbcast:8 row_mask:0xf bank_mask:0xf
    v_mul_f32_dpp v39, v15, v55 row_newbcast:8 row_mask:0xf bank_mask:0xf
    v_add_f32 v32, v32, v36
    v_add_f32 v33, v33, v37
    v_add_f32 v34, v34, v38
    v_add_f32 v35, v35, v39
    v_rcp_f32 v12, v33
    s_nop 1
    v_mul_f32_dpp v32, v12, v32 row_newbcast:8 row_mask:0xf bank_mask:0xf
    v_mul_f32_dpp v33, v12, v33 row_newbcast:8 row_mask:0xf bank_mask:0xf
    v_mul_f32_dpp v34, v12, v34 row_newbcast:8 row_mask:0xf bank_mask:0xf
    v_mul_f32_dpp v35, v12, v35 row_newbcast:8 row_mask:0xf bank_mask:0xf
    v_cvt_pk_bf16_f32 v32, v32, v32
    v_cvt_pk_bf16_f32 v33, v33, v33
    v_cvt_pk_bf16_f32 v34, v34, v34
    v_cvt_pk_bf16_f32 v35, v35, v35
    s_mov_b64 exec, s[40:41]
    global_store_short v13, v32, s[10:11] offset:0
    global_store_short v13, v33, s[10:11] offset:16
    global_store_short v13, v34, s[10:11] offset:32
    global_store_short v13, v35, s[10:11] offset:48
L_exit:
L_end1:
    s_endpgm
.section .rodata,"a"
.p2align 6
.amdhsa_kernel standalone__softmax_full_bidir__decode_kernel
  .amdhsa_next_free_vgpr 184
  .amdhsa_next_free_sgpr 64
  .amdhsa_accum_offset 184
  .amdhsa_group_segment_fixed_size 0
  .amdhsa_kernarg_size 48
  .amdhsa_user_sgpr_count 2
  .amdhsa_user_sgpr_kernarg_segment_ptr 1
  .amdhsa_system_sgpr_workgroup_id_x 1
.end_amdhsa_kernel
```
